```python
import torch

def _softmax(x, axis=-1):
    return torch.softmax(x, dim=axis)
def _gelu(x):
    return torch.nn.functional.gelu(x, approximate="tanh")
def _silu(x):
    return torch.nn.functional.silu(x)
def _sigmoid(x):
    return torch.sigmoid(x)
def _layernorm(x, axis=-1, eps=1e-5):
    m = x.mean(dim=axis, keepdim=True)
    v = x.var(dim=axis, keepdim=True, unbiased=False)
    return (x - m) / torch.sqrt(v + eps)
def _scatter_add(tgt, idx, src, axis=0):
    return tgt.clone().index_add_(axis, idx, src)
def _segment_sum(src, seg, n):
    out = torch.zeros((n,) + src.shape[1:], dtype=src.dtype)
    return out.index_add_(0, seg, src)
def _pad(x, pw):
    flat = tuple(v for pair in reversed(pw) for v in pair)
    return torch.nn.functional.pad(x, flat)

kernel_name = 'standalone__kv_cache_quant_int4_int2_kv_with_per_channel_or_per_token_scales__decode'

def setup_inputs():

    _w = (lambda a: (lambda t: t.to(torch.bfloat16) if t.is_floating_point() else t)(torch.as_tensor(a)))
    B = 1
    Sq = 1
    Skv = 65536
    Hq = 32
    Hkv = 4
    Dh = 128
    bits = 2
    G = 128
    if G <= 0 or G >= Skv:
        G = max(1, Skv // 2)
    Skv = (Skv // G) * G
    ngk = Skv // G
    qmax = (1 << bits) - 1
    return {
        "q": _w((lambda *s: torch.randn(*s, dtype=torch.bfloat16) * 3.2)(B, Hq, Sq, Dh)),
        "qk": _w(torch.randint(0, qmax + 1, (B, Hkv, Skv, Dh)).to(torch.int32)),
        "qv": _w(torch.randint(0, qmax + 1, (B, Hkv, Skv, Dh)).to(torch.int32)),
        "k_scales": _w(torch.abs((lambda *s: torch.randn(*s, dtype=torch.bfloat16) * 3.2)(B, Hkv, ngk, Dh)) * 0.05 + 0.02),
        "k_zeros": _w((lambda *s: torch.randn(*s, dtype=torch.bfloat16) * 3.2)(B, Hkv, ngk, Dh) + float(qmax) / 2.0),
        "v_scales": _w(torch.abs((lambda *s: torch.randn(*s, dtype=torch.bfloat16) * 0.05)(B, Hkv, Skv, 1)) * 0.05 + 0.02),
        "v_zeros": _w((lambda *s: torch.randn(*s, dtype=torch.bfloat16) * 0.05)(B, Hkv, Skv, 1) + float(qmax) / 2.0),
    }

def reference(q, qk, qv, k_scales, k_zeros, v_scales, v_zeros):
    B, Hq, Sq, Dh = q.shape
    Hkv, Skv = qk.shape[1], qk.shape[2]
    ngk = k_scales.shape[2]
    G = Skv // ngk
    ks = (lambda x, n, axis: torch.repeat_interleave(x, n, dim=axis))(k_scales, G, axis=2)
    kz = (lambda x, n, axis: torch.repeat_interleave(x, n, dim=axis))(k_zeros, G, axis=2)
    k = ((lambda x, dt: x.to(dt))(qk, q.dtype) - kz) * ks
    v = ((lambda x, dt: x.to(dt))(qv, q.dtype) - v_zeros) * v_scales
    rep = Hq // Hkv
    if rep > 1:
        k = (lambda x, n, axis: torch.repeat_interleave(x, n, dim=axis))(k, rep, axis=1)
        v = (lambda x, n, axis: torch.repeat_interleave(x, n, dim=axis))(v, rep, axis=1)
    scale = float(Dh) ** -0.5
    logits = torch.einsum("bhqd,bhkd->bhqk", q, k) * scale
    p = _softmax(logits, axis=-1)
    o = torch.einsum("bhqk,bhkd->bhqd", p, v)
    return o
```

```asm
; @launch kernel=standalone__kv_cache_quant_int4_int2_kv_with_per_channel_or_per_token_scales__decode_kernel grid=(256,1,1) block=(512,1,1) lds=158208
; @launch kernel=standalone__kv_cache_quant_int4_int2_kv_with_per_channel_or_per_token_scales__decode_comb_kernel grid=(128,1,1) block=(64,1,1) lds=0
.amdgcn_target "amdgcn-amd-amdhsa--gfx950"
.text
.globl standalone__kv_cache_quant_int4_int2_kv_with_per_channel_or_per_token_scales__decode_kernel
.p2align 8
.type standalone__kv_cache_quant_int4_int2_kv_with_per_channel_or_per_token_scales__decode_kernel,@function
standalone__kv_cache_quant_int4_int2_kv_with_per_channel_or_per_token_scales__decode_kernel:
    s_cmp_ge_u32 s2, 256
    s_cbranch_scc1 L_done
    s_load_dwordx4 s[16:19], s[0:1], 8
    s_load_dwordx8 s[20:27], s[0:1], 24
    s_load_dwordx2 s[28:29], s[0:1], 0
    s_load_dwordx2 s[30:31], s[0:1], 72
    v_lshrrev_b32 v2, 6, v0
    v_and_b32 v0, 63, v0
    v_readfirstlane_b32 s3, v2
    v_lshrrev_b32 v3, 4, v0
    v_and_b32 v4, 15, v0
    v_lshlrev_b32 v1, 9, v3
    v_lshl_add_u32 v1, v4, 4, v1
    s_lshr_b32 s4, s2, 6
    s_bfe_u32 s5, s2, 0x10000
    s_lshl_b32 s5, s5, 14
    s_bfe_u32 s6, s2, 0x10001
    s_lshl_b32 s6, s6, 19
    s_or_b32 s5, s5, s6
    s_bfe_u32 s6, s2, 0x10002
    s_lshl_b32 s6, s6, 17
    s_or_b32 s5, s5, s6
    s_bfe_u32 s6, s2, 0x20003
    s_lshl_b32 s6, s6, 20
    s_or_b32 s5, s5, s6
    s_bfe_u32 s6, s2, 0x10005
    s_lshl_b32 s6, s6, 16
    s_or_b32 s5, s5, s6
    s_bfe_u32 s7, s3, 0x10000
    s_lshl_b32 s7, s7, 13
    s_bfe_u32 s6, s3, 0x10001
    s_lshl_b32 s6, s6, 15
    s_or_b32 s7, s7, s6
    s_bfe_u32 s6, s3, 0x10002
    s_lshl_b32 s6, s6, 18
    s_or_b32 s7, s7, s6
    s_lshl_b32 s6, s4, 25
    s_or_b32 s7, s7, s5
    s_or_b32 s7, s7, s6
    s_mov_b32 s40, s7
    s_add_u32 s41, s7, 4096
    s_add_u32 s42, s7, 4194304
    s_add_u32 s43, s7, 4198400
    s_mov_b32 s14, 0x8000000
    s_mov_b32 s15, 0x20000
    v_lshlrev_b32 v5, 4, v4
    v_bfe_u32 v9, v3, 0, 1
    v_lshl_add_u32 v5, v9, 14, v5
    v_bfe_u32 v9, v3, 1, 1
    v_lshl_add_u32 v5, v9, 15, v5
    s_lshr_b32 s10, s7, 8
    s_andn2_b32 s8, s10, 0xff
    s_add_u32 s9, s8, 65536
    s_waitcnt lgkmcnt(0)
    s_mov_b32 s12, s16
    s_mov_b32 s13, s17
    buffer_load_dwordx4 v[156:159], v1, s[12:15], s40 offen offset:0 nt
    buffer_load_dwordx4 v[160:163], v1, s[12:15], s40 offen offset:2048 nt
    buffer_load_dwordx4 v[164:167], v1, s[12:15], s40 offen offset:256 nt
    buffer_load_dwordx4 v[168:171], v1, s[12:15], s40 offen offset:2304 nt
    buffer_load_dwordx4 v[172:175], v1, s[12:15], s41 offen offset:0 nt
    buffer_load_dwordx4 v[176:179], v1, s[12:15], s41 offen offset:2048 nt
    buffer_load_dwordx4 v[180:183], v1, s[12:15], s41 offen offset:256 nt
    buffer_load_dwordx4 v[184:187], v1, s[12:15], s41 offen offset:2304 nt
    s_mov_b32 s44, s22
    s_mov_b32 s45, s23
    s_mov_b32 s46, 0x80000
    s_mov_b32 s47, 0x20000
    s_mov_b32 s48, s20
    s_mov_b32 s49, s21
    s_mov_b32 s50, 0x80000
    s_mov_b32 s51, 0x20000
    buffer_load_dwordx4 v[100:103], v5, s[44:47], s8 offen
    buffer_load_dwordx4 v[104:107], v5, s[48:51], s8 offen
    buffer_load_dwordx4 v[108:111], v5, s[44:47], s9 offen
    buffer_load_dwordx4 v[112:115], v5, s[48:51], s9 offen
    s_mov_b32 s64, 4
    s_bitcmp1_b32 s2, 0
    s_cbranch_scc1 L_sk_odd
    s_cmp_ge_u32 s3, 1
    s_cbranch_scc1 L_sk_done
    s_mov_b32 s64, 5
    s_add_u32 s66, s3, 7
    s_bfe_u32 s65, s66, 0x10000
    s_lshl_b32 s65, s65, 13
    s_bfe_u32 s6, s66, 0x10001
    s_lshl_b32 s6, s6, 15
    s_or_b32 s65, s65, s6
    s_bfe_u32 s6, s66, 0x10002
    s_lshl_b32 s6, s6, 18
    s_or_b32 s65, s65, s6
    s_lshl_b32 s6, s4, 25
    s_or_b32 s65, s65, s5
    s_or_b32 s65, s65, s6
    s_or_b32 s65, s65, 16384
    s_lshr_b32 s67, s65, 8
    s_andn2_b32 s66, s67, 0xff
    s_add_u32 s66, s66, 65536
    s_or_b32 s65, s65, 25165824
    buffer_load_dwordx4 v[116:119], v5, s[44:47], s66 offen
    buffer_load_dwordx4 v[120:123], v5, s[48:51], s66 offen
    s_branch L_sk_done
L_sk_odd:
    s_cmp_ge_u32 s3, 7
    s_cselect_b32 s64, 3, 4
L_sk_done:
    v_and_b32 v7, 7, v0
    v_lshlrev_b32 v8, 8, v7
    v_lshl_add_u32 v8, v3, 4, v8
    s_lshl_b32 s11, s4, 11
    s_mov_b32 s60, s28
    s_mov_b32 s61, s29
    s_mov_b32 s62, 0x2000
    s_mov_b32 s63, 0x20000
    buffer_load_dwordx4 v[20:23], v8, s[60:63], s11 offen offset:0
    buffer_load_dwordx4 v[24:27], v8, s[60:63], s11 offen offset:64
    buffer_load_dwordx4 v[28:31], v8, s[60:63], s11 offen offset:128
    buffer_load_dwordx4 v[32:35], v8, s[60:63], s11 offen offset:192
    buffer_load_dwordx4 v[188:191], v1, s[12:15], s42 offen offset:0 nt
    buffer_load_dwordx4 v[192:195], v1, s[12:15], s42 offen offset:2048 nt
    buffer_load_dwordx4 v[196:199], v1, s[12:15], s42 offen offset:256 nt
    buffer_load_dwordx4 v[200:203], v1, s[12:15], s42 offen offset:2304 nt
    buffer_load_dwordx4 v[204:207], v1, s[12:15], s43 offen offset:0 nt
    buffer_load_dwordx4 v[208:211], v1, s[12:15], s43 offen offset:2048 nt
    buffer_load_dwordx4 v[212:215], v1, s[12:15], s43 offen offset:256 nt
    buffer_load_dwordx4 v[216:219], v1, s[12:15], s43 offen offset:2304 nt
    v_lshlrev_b32 v6, 2, v7
    v_bfe_u32 v9, v0, 3, 1
    v_lshl_add_u32 v6, v9, 14, v6
    v_bfe_u32 v9, v0, 4, 1
    v_lshl_add_u32 v6, v9, 15, v6
    v_bfe_u32 v9, v0, 5, 1
    v_lshl_add_u32 v6, v9, 16, v6
    s_mov_b32 s52, s24
    s_mov_b32 s53, s25
    s_mov_b32 s54, 0x80000
    s_mov_b32 s55, 0x20000
    s_mov_b32 s56, s26
    s_mov_b32 s57, s27
    s_mov_b32 s58, 0x80000
    s_mov_b32 s59, 0x20000
    buffer_load_dword v220, v6, s[56:59], s10 offen nt
    buffer_load_dword v221, v6, s[52:55], s10 offen nt
    s_cmp_lg_u32 s64, 5
    s_cbranch_scc1 L_sk2
    buffer_load_dword v224, v6, s[56:59], s67 offen nt
    buffer_load_dword v225, v6, s[52:55], s67 offen nt
L_sk2:
    s_lshl_b32 s32, s3, 13
    v_lshrrev_b32 v8, 1, v4
    v_lshlrev_b32 v9, 2, v3
    v_xor_b32 v8, v8, v9
    v_lshlrev_b32 v8, 4, v8
    v_lshl_add_u32 v8, v3, 10, v8
    v_and_b32 v9, 1, v4
    v_lshl_add_u32 v8, v9, 3, v8
    v_add_u32 v19, s32, v8
    v_xor_b32 v8, v3, v4
    v_lshlrev_b32 v8, 4, v8
    v_lshl_add_u32 v8, v4, 8, v8
    v_add_u32 v8, s32, v8
    v_xor_b32 v10, 0, v8
    v_xor_b32 v11, 64, v8
    v_xor_b32 v12, 128, v8
    v_xor_b32 v13, 192, v8
    s_mul_i32 s34, s3, 5120
    s_add_u32 s35, s34, 106496
    s_add_u32 s34, s34, 65536
    v_lshlrev_b32 v14, 3, v4
    v_add_u32 v14, s35, v14
    s_mul_i32 s33, s3, 1280
    s_add_u32 s33, s33, 147456
    v_lshlrev_b32 v15, 4, v3
    v_add_u32 v15, s33, v15
    v_lshlrev_b32 v16, 4, v0
    v_add_u32 v16, s34, v16
    v_lshlrev_b32 v140, 9, v3
    v_lshl_add_u32 v140, v4, 4, v140
    v_add_u32 v140, s35, v140
    v_lshrrev_b32 v222, 3, v0
    v_lshlrev_b32 v222, 6, v222
    v_and_b32 v150, 1, v0
    v_lshl_add_u32 v222, v150, 5, v222
    v_bfe_u32 v150, v0, 1, 2
    v_lshl_add_u32 v222, v150, 2, v222
    v_add_u32 v222, s33, v222
    v_xor_b32 v2, 0, v19
    v_xor_b32 v3, 16, v19
    v_xor_b32 v4, 128, v19
    v_xor_b32 v5, 144, v19
    v_xor_b32 v6, 32, v19
    v_xor_b32 v7, 48, v19
    v_xor_b32 v8, 160, v19
    v_xor_b32 v9, 176, v19
    v_mov_b32 v18, 0xff800000
    v_mov_b32 v19, 0
    v_mov_b32 v68, 0
    v_mov_b32 v69, 0
    v_mov_b32 v70, 0
    v_mov_b32 v71, 0
    v_mov_b32 v72, 0
    v_mov_b32 v73, 0
    v_mov_b32 v74, 0
    v_mov_b32 v75, 0
    v_mov_b32 v76, 0
    v_mov_b32 v77, 0
    v_mov_b32 v78, 0
    v_mov_b32 v79, 0
    v_mov_b32 v80, 0
    v_mov_b32 v81, 0
    v_mov_b32 v82, 0
    v_mov_b32 v83, 0
    v_mov_b32 v84, 0
    v_mov_b32 v85, 0
    v_mov_b32 v86, 0
    v_mov_b32 v87, 0
    v_mov_b32 v88, 0
    v_mov_b32 v89, 0
    v_mov_b32 v90, 0
    v_mov_b32 v91, 0
    v_mov_b32 v92, 0
    v_mov_b32 v93, 0
    v_mov_b32 v94, 0
    v_mov_b32 v95, 0
    v_mov_b32 v96, 0
    v_mov_b32 v97, 0
    v_mov_b32 v98, 0
    v_mov_b32 v99, 0
    s_mov_b32 s36, 0x3db504f3
    s_mov_b32 s37, 0x3fb8aa3b
    s_mov_b32 s38, 0
    s_waitcnt vmcnt(14)
    s_cmp_lg_u32 s64, 5
    s_cbranch_scc1 L_sk3
    ds_write_b128 v140, v[116:119] offset:3072
    ds_write_b128 v140, v[120:123] offset:3328
L_sk3:
    ds_write_b128 v140, v[100:103] offset:0
    ds_write_b128 v140, v[104:107] offset:256
    ds_write_b128 v140, v[108:111] offset:2048
    ds_write_b128 v140, v[112:115] offset:2304
L_k:
    ds_read2_b64 v[226:229], v14 offset0:0 offset1:16
    ds_read2_b64 v[230:233], v14 offset0:32 offset1:48
    ds_read2_b64 v[234:237], v14 offset0:64 offset1:80
    ds_read2_b64 v[238:241], v14 offset0:96 offset1:112
    s_add_u32 s38, s38, 1
    s_add_u32 s40, s40, 8388608
    s_cmp_eq_u32 s38, 4
    s_cselect_b32 s40, s65, s40
    s_cmp_lt_u32 s38, s64
    s_cselect_b32 s12, s16, s18
    s_cselect_b32 s13, s17, s19
    s_cselect_b32 s40, s40, s7
    s_add_u32 s41, s40, 4096
    s_add_u32 s42, s40, 4194304
    s_add_u32 s43, s40, 4198400
    s_waitcnt vmcnt(15)
    v_cvt_f32_i32 v140, v156
    v_cvt_f32_i32 v141, v157
    v_cvt_f32_i32 v142, v158
    v_cvt_f32_i32 v143, v159
    buffer_load_dwordx4 v[156:159], v1, s[12:15], s40 offen offset:0 nt
    s_waitcnt lgkmcnt(0)
    v_lshlrev_b32 v36, 16, v226
    v_and_b32 v37, 0xffff0000, v226
    v_lshlrev_b32 v38, 16, v227
    v_and_b32 v39, 0xffff0000, v227
    v_lshlrev_b32 v40, 16, v228
    v_and_b32 v41, 0xffff0000, v228
    v_lshlrev_b32 v42, 16, v229
    v_and_b32 v43, 0xffff0000, v229
    v_lshlrev_b32 v44, 16, v230
    v_and_b32 v45, 0xffff0000, v230
    v_lshlrev_b32 v46, 16, v231
    v_and_b32 v47, 0xffff0000, v231
    v_lshlrev_b32 v48, 16, v232
    v_and_b32 v49, 0xffff0000, v232
    v_lshlrev_b32 v50, 16, v233
    v_and_b32 v51, 0xffff0000, v233
    v_lshlrev_b32 v52, 16, v234
    v_and_b32 v53, 0xffff0000, v234
    v_lshlrev_b32 v54, 16, v235
    v_and_b32 v55, 0xffff0000, v235
    v_lshlrev_b32 v56, 16, v236
    v_and_b32 v57, 0xffff0000, v236
    v_lshlrev_b32 v58, 16, v237
    v_and_b32 v59, 0xffff0000, v237
    v_lshlrev_b32 v60, 16, v238
    v_and_b32 v61, 0xffff0000, v238
    v_lshlrev_b32 v62, 16, v239
    v_and_b32 v63, 0xffff0000, v239
    v_lshlrev_b32 v64, 16, v240
    v_and_b32 v65, 0xffff0000, v240
    v_lshlrev_b32 v66, 16, v241
    v_and_b32 v67, 0xffff0000, v241
    v_pk_add_f32 v[140:141], v[140:141], v[36:37] neg_lo:[0,1] neg_hi:[0,1]
    v_pk_add_f32 v[142:143], v[142:143], v[38:39] neg_lo:[0,1] neg_hi:[0,1]
    v_cvt_pk_bf16_f32 v154, v140, v141
    v_cvt_pk_bf16_f32 v155, v142, v143
    v_lshlrev_b32 v140, 16, v154
    v_and_b32 v141, 0xffff0000, v154
    v_lshlrev_b32 v142, 16, v155
    v_and_b32 v143, 0xffff0000, v155
    v_pk_mul_f32 v[140:141], v[140:141], v[44:45]
    v_pk_mul_f32 v[142:143], v[142:143], v[46:47]
    v_cvt_pk_bf16_f32 v140, v140, v141
    v_cvt_pk_bf16_f32 v141, v142, v143
    ds_write_b64 v2, v[140:141] offset:0
    s_waitcnt vmcnt(15)
    v_cvt_f32_i32 v144, v160
    v_cvt_f32_i32 v145, v161
    v_cvt_f32_i32 v146, v162
    v_cvt_f32_i32 v147, v163
    buffer_load_dwordx4 v[160:163], v1, s[12:15], s40 offen offset:2048 nt
    v_pk_add_f32 v[144:145], v[144:145], v[36:37] neg_lo:[0,1] neg_hi:[0,1]
    v_pk_add_f32 v[146:147], v[146:147], v[38:39] neg_lo:[0,1] neg_hi:[0,1]
    v_cvt_pk_bf16_f32 v154, v144, v145
    v_cvt_pk_bf16_f32 v155, v146, v147
    v_lshlrev_b32 v144, 16, v154
    v_and_b32 v145, 0xffff0000, v154
    v_lshlrev_b32 v146, 16, v155
    v_and_b32 v147, 0xffff0000, v155
    v_pk_mul_f32 v[144:145], v[144:145], v[44:45]
    v_pk_mul_f32 v[146:147], v[146:147], v[46:47]
    v_cvt_pk_bf16_f32 v144, v144, v145
    v_cvt_pk_bf16_f32 v145, v146, v147
    ds_write_b64 v3, v[144:145] offset:256
    s_waitcnt vmcnt(15)
    v_cvt_f32_i32 v140, v164
    v_cvt_f32_i32 v141, v165
    v_cvt_f32_i32 v142, v166
    v_cvt_f32_i32 v143, v167
    buffer_load_dwordx4 v[164:167], v1, s[12:15], s40 offen offset:256 nt
    v_pk_add_f32 v[140:141], v[140:141], v[40:41] neg_lo:[0,1] neg_hi:[0,1]
    v_pk_add_f32 v[142:143], v[142:143], v[42:43] neg_lo:[0,1] neg_hi:[0,1]
    v_cvt_pk_bf16_f32 v154, v140, v141
    v_cvt_pk_bf16_f32 v155, v142, v143
    v_lshlrev_b32 v140, 16, v154
    v_and_b32 v141, 0xffff0000, v154
    v_lshlrev_b32 v142, 16, v155
    v_and_b32 v143, 0xffff0000, v155
    v_pk_mul_f32 v[140:141], v[140:141], v[48:49]
    v_pk_mul_f32 v[142:143], v[142:143], v[50:51]
    v_cvt_pk_bf16_f32 v140, v140, v141
    v_cvt_pk_bf16_f32 v141, v142, v143
    ds_write_b64 v4, v[140:141] offset:0
    s_waitcnt vmcnt(15)
    v_cvt_f32_i32 v144, v168
    v_cvt_f32_i32 v145, v169
    v_cvt_f32_i32 v146, v170
    v_cvt_f32_i32 v147, v171
    buffer_load_dwordx4 v[168:171], v1, s[12:15], s40 offen offset:2304 nt
    v_pk_add_f32 v[144:145], v[144:145], v[40:41] neg_lo:[0,1] neg_hi:[0,1]
    v_pk_add_f32 v[146:147], v[146:147], v[42:43] neg_lo:[0,1] neg_hi:[0,1]
    v_cvt_pk_bf16_f32 v154, v144, v145
    v_cvt_pk_bf16_f32 v155, v146, v147
    v_lshlrev_b32 v144, 16, v154
    v_and_b32 v145, 0xffff0000, v154
    v_lshlrev_b32 v146, 16, v155
    v_and_b32 v147, 0xffff0000, v155
    v_pk_mul_f32 v[144:145], v[144:145], v[48:49]
    v_pk_mul_f32 v[146:147], v[146:147], v[50:51]
    v_cvt_pk_bf16_f32 v144, v144, v145
    v_cvt_pk_bf16_f32 v145, v146, v147
    ds_write_b64 v5, v[144:145] offset:256
    s_waitcnt vmcnt(15)
    v_cvt_f32_i32 v140, v172
    v_cvt_f32_i32 v141, v173
    v_cvt_f32_i32 v142, v174
    v_cvt_f32_i32 v143, v175
    buffer_load_dwordx4 v[172:175], v1, s[12:15], s41 offen offset:0 nt
    v_pk_add_f32 v[140:141], v[140:141], v[36:37] neg_lo:[0,1] neg_hi:[0,1]
    v_pk_add_f32 v[142:143], v[142:143], v[38:39] neg_lo:[0,1] neg_hi:[0,1]
    v_cvt_pk_bf16_f32 v154, v140, v141
    v_cvt_pk_bf16_f32 v155, v142, v143
    v_lshlrev_b32 v140, 16, v154
    v_and_b32 v141, 0xffff0000, v154
    v_lshlrev_b32 v142, 16, v155
    v_and_b32 v143, 0xffff0000, v155
    v_pk_mul_f32 v[140:141], v[140:141], v[44:45]
    v_pk_mul_f32 v[142:143], v[142:143], v[46:47]
    v_cvt_pk_bf16_f32 v140, v140, v141
    v_cvt_pk_bf16_f32 v141, v142, v143
    ds_write_b64 v6, v[140:141] offset:512
    s_waitcnt vmcnt(15)
    v_cvt_f32_i32 v144, v176
    v_cvt_f32_i32 v145, v177
    v_cvt_f32_i32 v146, v178
    v_cvt_f32_i32 v147, v179
    buffer_load_dwordx4 v[176:179], v1, s[12:15], s41 offen offset:2048 nt
    v_pk_add_f32 v[144:145], v[144:145], v[36:37] neg_lo:[0,1] neg_hi:[0,1]
    v_pk_add_f32 v[146:147], v[146:147], v[38:39] neg_lo:[0,1] neg_hi:[0,1]
    v_cvt_pk_bf16_f32 v154, v144, v145
    v_cvt_pk_bf16_f32 v155, v146, v147
    v_lshlrev_b32 v144, 16, v154
    v_and_b32 v145, 0xffff0000, v154
    v_lshlrev_b32 v146, 16, v155
    v_and_b32 v147, 0xffff0000, v155
    v_pk_mul_f32 v[144:145], v[144:145], v[44:45]
    v_pk_mul_f32 v[146:147], v[146:147], v[46:47]
    v_cvt_pk_bf16_f32 v144, v144, v145
    v_cvt_pk_bf16_f32 v145, v146, v147
    ds_write_b64 v7, v[144:145] offset:768
    s_waitcnt vmcnt(15)
    v_cvt_f32_i32 v140, v180
    v_cvt_f32_i32 v141, v181
    v_cvt_f32_i32 v142, v182
    v_cvt_f32_i32 v143, v183
    buffer_load_dwordx4 v[180:183], v1, s[12:15], s41 offen offset:256 nt
    v_pk_add_f32 v[140:141], v[140:141], v[40:41] neg_lo:[0,1] neg_hi:[0,1]
    v_pk_add_f32 v[142:143], v[142:143], v[42:43] neg_lo:[0,1] neg_hi:[0,1]
    v_cvt_pk_bf16_f32 v154, v140, v141
    v_cvt_pk_bf16_f32 v155, v142, v143
    v_lshlrev_b32 v140, 16, v154
    v_and_b32 v141, 0xffff0000, v154
    v_lshlrev_b32 v142, 16, v155
    v_and_b32 v143, 0xffff0000, v155
    v_pk_mul_f32 v[140:141], v[140:141], v[48:49]
    v_pk_mul_f32 v[142:143], v[142:143], v[50:51]
    v_cvt_pk_bf16_f32 v140, v140, v141
    v_cvt_pk_bf16_f32 v141, v142, v143
    ds_write_b64 v8, v[140:141] offset:512
    s_waitcnt vmcnt(15)
    v_cvt_f32_i32 v144, v184
    v_cvt_f32_i32 v145, v185
    v_cvt_f32_i32 v146, v186
    v_cvt_f32_i32 v147, v187
    buffer_load_dwordx4 v[184:187], v1, s[12:15], s41 offen offset:2304 nt
    v_pk_add_f32 v[144:145], v[144:145], v[40:41] neg_lo:[0,1] neg_hi:[0,1]
    v_pk_add_f32 v[146:147], v[146:147], v[42:43] neg_lo:[0,1] neg_hi:[0,1]
    v_cvt_pk_bf16_f32 v154, v144, v145
    v_cvt_pk_bf16_f32 v155, v146, v147
    v_lshlrev_b32 v144, 16, v154
    v_and_b32 v145, 0xffff0000, v154
    v_lshlrev_b32 v146, 16, v155
    v_and_b32 v147, 0xffff0000, v155
    v_pk_mul_f32 v[144:145], v[144:145], v[48:49]
    v_pk_mul_f32 v[146:147], v[146:147], v[50:51]
    v_cvt_pk_bf16_f32 v144, v144, v145
    v_cvt_pk_bf16_f32 v145, v146, v147
    ds_write_b64 v9, v[144:145] offset:768
    ds_read_b128 v[100:103], v10 offset:0
    ds_read_b128 v[104:107], v11 offset:0
    ds_read_b128 v[108:111], v12 offset:0
    ds_read_b128 v[112:115], v13 offset:0
    s_waitcnt vmcnt(15)
    v_cvt_f32_i32 v140, v188
    v_cvt_f32_i32 v141, v189
    v_cvt_f32_i32 v142, v190
    v_cvt_f32_i32 v143, v191
    buffer_load_dwordx4 v[188:191], v1, s[12:15], s42 offen offset:0 nt
    v_pk_add_f32 v[140:141], v[140:141], v[52:53] neg_lo:[0,1] neg_hi:[0,1]
    v_pk_add_f32 v[142:143], v[142:143], v[54:55] neg_lo:[0,1] neg_hi:[0,1]
    v_cvt_pk_bf16_f32 v154, v140, v141
    v_cvt_pk_bf16_f32 v155, v142, v143
    v_lshlrev_b32 v140, 16, v154
    v_and_b32 v141, 0xffff0000, v154
    v_lshlrev_b32 v142, 16, v155
    v_and_b32 v143, 0xffff0000, v155
    v_pk_mul_f32 v[140:141], v[140:141], v[60:61]
    v_pk_mul_f32 v[142:143], v[142:143], v[62:63]
    v_cvt_pk_bf16_f32 v140, v140, v141
    v_cvt_pk_bf16_f32 v141, v142, v143
    ds_write_b64 v2, v[140:141] offset:4096
    s_waitcnt vmcnt(15)
    v_cvt_f32_i32 v144, v192
    v_cvt_f32_i32 v145, v193
    v_cvt_f32_i32 v146, v194
    v_cvt_f32_i32 v147, v195
    buffer_load_dwordx4 v[192:195], v1, s[12:15], s42 offen offset:2048 nt
    v_pk_add_f32 v[144:145], v[144:145], v[52:53] neg_lo:[0,1] neg_hi:[0,1]
    v_pk_add_f32 v[146:147], v[146:147], v[54:55] neg_lo:[0,1] neg_hi:[0,1]
    v_cvt_pk_bf16_f32 v154, v144, v145
    v_cvt_pk_bf16_f32 v155, v146, v147
    v_lshlrev_b32 v144, 16, v154
    v_and_b32 v145, 0xffff0000, v154
    v_lshlrev_b32 v146, 16, v155
    v_and_b32 v147, 0xffff0000, v155
    v_pk_mul_f32 v[144:145], v[144:145], v[60:61]
    v_pk_mul_f32 v[146:147], v[146:147], v[62:63]
    v_cvt_pk_bf16_f32 v144, v144, v145
    v_cvt_pk_bf16_f32 v145, v146, v147
    ds_write_b64 v3, v[144:145] offset:4352
    s_waitcnt lgkmcnt(2)
    v_mfma_f32_16x16x32_bf16 v[132:135], v[100:103], v[20:23], 0
    v_mfma_f32_16x16x32_bf16 v[132:135], v[104:107], v[24:27], v[132:135]
    v_mfma_f32_16x16x32_bf16 v[132:135], v[108:111], v[28:31], v[132:135]
    v_mfma_f32_16x16x32_bf16 v[132:135], v[112:115], v[32:35], v[132:135]
    s_waitcnt vmcnt(15)
    v_cvt_f32_i32 v140, v196
    v_cvt_f32_i32 v141, v197
    v_cvt_f32_i32 v142, v198
    v_cvt_f32_i32 v143, v199
    buffer_load_dwordx4 v[196:199], v1, s[12:15], s42 offen offset:256 nt
    v_pk_add_f32 v[140:141], v[140:141], v[56:57] neg_lo:[0,1] neg_hi:[0,1]
    v_pk_add_f32 v[142:143], v[142:143], v[58:59] neg_lo:[0,1] neg_hi:[0,1]
    v_cvt_pk_bf16_f32 v154, v140, v141
    v_cvt_pk_bf16_f32 v155, v142, v143
    v_lshlrev_b32 v140, 16, v154
    v_and_b32 v141, 0xffff0000, v154
    v_lshlrev_b32 v142, 16, v155
    v_and_b32 v143, 0xffff0000, v155
    v_pk_mul_f32 v[140:141], v[140:141], v[64:65]
    v_pk_mul_f32 v[142:143], v[142:143], v[66:67]
    v_cvt_pk_bf16_f32 v140, v140, v141
    v_cvt_pk_bf16_f32 v141, v142, v143
    ds_write_b64 v4, v[140:141] offset:4096
    s_waitcnt vmcnt(15)
    v_cvt_f32_i32 v144, v200
    v_cvt_f32_i32 v145, v201
    v_cvt_f32_i32 v146, v202
    v_cvt_f32_i32 v147, v203
    buffer_load_dwordx4 v[200:203], v1, s[12:15], s42 offen offset:2304 nt
    v_pk_add_f32 v[144:145], v[144:145], v[56:57] neg_lo:[0,1] neg_hi:[0,1]
    v_pk_add_f32 v[146:147], v[146:147], v[58:59] neg_lo:[0,1] neg_hi:[0,1]
    v_cvt_pk_bf16_f32 v154, v144, v145
    v_cvt_pk_bf16_f32 v155, v146, v147
    v_lshlrev_b32 v144, 16, v154
    v_and_b32 v145, 0xffff0000, v154
    v_lshlrev_b32 v146, 16, v155
    v_and_b32 v147, 0xffff0000, v155
    v_pk_mul_f32 v[144:145], v[144:145], v[64:65]
    v_pk_mul_f32 v[146:147], v[146:147], v[66:67]
    v_cvt_pk_bf16_f32 v144, v144, v145
    v_cvt_pk_bf16_f32 v145, v146, v147
    ds_write_b64 v5, v[144:145] offset:4352
    v_cvt_pk_bf16_f32 v152, v132, v133
    v_cvt_pk_bf16_f32 v153, v134, v135
    v_lshlrev_b32 v148, 16, v152
    v_and_b32 v149, 0xffff0000, v152
    v_lshlrev_b32 v150, 16, v153
    v_and_b32 v151, 0xffff0000, v153
    v_mul_f32 v148, s36, v148
    v_mul_f32 v149, s36, v149
    v_mul_f32 v150, s36, v150
    v_mul_f32 v151, s36, v151
    v_cvt_pk_bf16_f32 v152, v148, v149
    v_cvt_pk_bf16_f32 v153, v150, v151
    v_max3_f32 v18, v18, v148, v149
    v_max3_f32 v18, v18, v150, v151
    ds_write_b64 v16, v[152:153] offset:0
    s_waitcnt vmcnt(15)
    v_cvt_f32_i32 v140, v204
    v_cvt_f32_i32 v141, v205
    v_cvt_f32_i32 v142, v206
    v_cvt_f32_i32 v143, v207
    buffer_load_dwordx4 v[204:207], v1, s[12:15], s43 offen offset:0 nt
    v_pk_add_f32 v[140:141], v[140:141], v[52:53] neg_lo:[0,1] neg_hi:[0,1]
    v_pk_add_f32 v[142:143], v[142:143], v[54:55] neg_lo:[0,1] neg_hi:[0,1]
    v_cvt_pk_bf16_f32 v154, v140, v141
    v_cvt_pk_bf16_f32 v155, v142, v143
    v_lshlrev_b32 v140, 16, v154
    v_and_b32 v141, 0xffff0000, v154
    v_lshlrev_b32 v142, 16, v155
    v_and_b32 v143, 0xffff0000, v155
    v_pk_mul_f32 v[140:141], v[140:141], v[60:61]
    v_pk_mul_f32 v[142:143], v[142:143], v[62:63]
    v_cvt_pk_bf16_f32 v140, v140, v141
    v_cvt_pk_bf16_f32 v141, v142, v143
    ds_write_b64 v6, v[140:141] offset:4608
    s_waitcnt vmcnt(15)
    v_cvt_f32_i32 v144, v208
    v_cvt_f32_i32 v145, v209
    v_cvt_f32_i32 v146, v210
    v_cvt_f32_i32 v147, v211
    buffer_load_dwordx4 v[208:211], v1, s[12:15], s43 offen offset:2048 nt
    v_pk_add_f32 v[144:145], v[144:145], v[52:53] neg_lo:[0,1] neg_hi:[0,1]
    v_pk_add_f32 v[146:147], v[146:147], v[54:55] neg_lo:[0,1] neg_hi:[0,1]
    v_cvt_pk_bf16_f32 v154, v144, v145
    v_cvt_pk_bf16_f32 v155, v146, v147
    v_lshlrev_b32 v144, 16, v154
    v_and_b32 v145, 0xffff0000, v154
    v_lshlrev_b32 v146, 16, v155
    v_and_b32 v147, 0xffff0000, v155
    v_pk_mul_f32 v[144:145], v[144:145], v[60:61]
    v_pk_mul_f32 v[146:147], v[146:147], v[62:63]
    v_cvt_pk_bf16_f32 v144, v144, v145
    v_cvt_pk_bf16_f32 v145, v146, v147
    ds_write_b64 v7, v[144:145] offset:4864
    s_waitcnt vmcnt(15)
    v_cvt_f32_i32 v140, v212
    v_cvt_f32_i32 v141, v213
    v_cvt_f32_i32 v142, v214
    v_cvt_f32_i32 v143, v215
    buffer_load_dwordx4 v[212:215], v1, s[12:15], s43 offen offset:256 nt
    v_pk_add_f32 v[140:141], v[140:141], v[56:57] neg_lo:[0,1] neg_hi:[0,1]
    v_pk_add_f32 v[142:143], v[142:143], v[58:59] neg_lo:[0,1] neg_hi:[0,1]
    v_cvt_pk_bf16_f32 v154, v140, v141
    v_cvt_pk_bf16_f32 v155, v142, v143
    v_lshlrev_b32 v140, 16, v154
    v_and_b32 v141, 0xffff0000, v154
    v_lshlrev_b32 v142, 16, v155
    v_and_b32 v143, 0xffff0000, v155
    v_pk_mul_f32 v[140:141], v[140:141], v[64:65]
    v_pk_mul_f32 v[142:143], v[142:143], v[66:67]
    v_cvt_pk_bf16_f32 v140, v140, v141
    v_cvt_pk_bf16_f32 v141, v142, v143
    ds_write_b64 v8, v[140:141] offset:4608
    s_waitcnt vmcnt(15)
    v_cvt_f32_i32 v144, v216
    v_cvt_f32_i32 v145, v217
    v_cvt_f32_i32 v146, v218
    v_cvt_f32_i32 v147, v219
    buffer_load_dwordx4 v[216:219], v1, s[12:15], s43 offen offset:2304 nt
    v_pk_add_f32 v[144:145], v[144:145], v[56:57] neg_lo:[0,1] neg_hi:[0,1]
    v_pk_add_f32 v[146:147], v[146:147], v[58:59] neg_lo:[0,1] neg_hi:[0,1]
    v_cvt_pk_bf16_f32 v154, v144, v145
    v_cvt_pk_bf16_f32 v155, v146, v147
    v_lshlrev_b32 v144, 16, v154
    v_and_b32 v145, 0xffff0000, v154
    v_lshlrev_b32 v146, 16, v155
    v_and_b32 v147, 0xffff0000, v155
    v_pk_mul_f32 v[144:145], v[144:145], v[64:65]
    v_pk_mul_f32 v[146:147], v[146:147], v[66:67]
    v_cvt_pk_bf16_f32 v144, v144, v145
    v_cvt_pk_bf16_f32 v145, v146, v147
    ds_write_b64 v9, v[144:145] offset:4864
    ds_read_b128 v[116:119], v10 offset:4096
    ds_read_b128 v[120:123], v11 offset:4096
    ds_read_b128 v[124:127], v12 offset:4096
    ds_read_b128 v[128:131], v13 offset:4096
    s_waitcnt lgkmcnt(0)
    v_mfma_f32_16x16x32_bf16 v[136:139], v[116:119], v[20:23], 0
    v_mfma_f32_16x16x32_bf16 v[136:139], v[120:123], v[24:27], v[136:139]
    v_mfma_f32_16x16x32_bf16 v[136:139], v[124:127], v[28:31], v[136:139]
    v_mfma_f32_16x16x32_bf16 v[136:139], v[128:131], v[32:35], v[136:139]
    v_add_u32 v14, 1024, v14
    s_nop 7
    v_cvt_pk_bf16_f32 v152, v136, v137
    v_cvt_pk_bf16_f32 v153, v138, v139
    v_lshlrev_b32 v148, 16, v152
    v_and_b32 v149, 0xffff0000, v152
    v_lshlrev_b32 v150, 16, v153
    v_and_b32 v151, 0xffff0000, v153
    v_mul_f32 v148, s36, v148
    v_mul_f32 v149, s36, v149
    v_mul_f32 v150, s36, v150
    v_mul_f32 v151, s36, v151
    v_cvt_pk_bf16_f32 v152, v148, v149
    v_cvt_pk_bf16_f32 v153, v150, v151
    v_max3_f32 v18, v18, v148, v149
    v_max3_f32 v18, v18, v150, v151
    ds_write_b64 v16, v[152:153] offset:8
    v_add_u32 v16, 1024, v16
    s_cmp_lt_u32 s38, s64
    s_cbranch_scc1 L_k
    s_lshl_b32 s39, s64, 10
    v_subrev_u32 v16, s39, v16
    s_sub_u32 s64, s64, 1
    s_cmp_lg_u32 s64, 4
    s_cbranch_scc1 L_sk4
    v_lshlrev_b32 v150, 16, v224
    v_and_b32 v151, 0xffff0000, v224
    v_lshlrev_b32 v152, 16, v225
    v_and_b32 v153, 0xffff0000, v225
    ds_write2_b32 v222, v150, v151 offset0:32 offset1:36
    ds_write2_b32 v222, v152, v153 offset0:192 offset1:196
L_sk4:
    v_lshlrev_b32 v150, 16, v220
    v_and_b32 v151, 0xffff0000, v220
    v_lshlrev_b32 v152, 16, v221
    v_and_b32 v153, 0xffff0000, v221
    ds_write2_b32 v222, v150, v151 offset0:0 offset1:4
    ds_write2_b32 v222, v152, v153 offset0:160 offset1:164
    v_mov_b32 v140, v18
    s_nop 1
    v_permlane32_swap_b32 v140, v18
    v_max_f32 v18, v18, v140
    v_mov_b32 v140, v18
    s_nop 1
    v_permlane16_swap_b32 v140, v18
    v_max_f32 v18, v18, v140
    v_cvt_pk_bf16_f32 v18, v18, v18
    v_and_b32 v18, 0xffff0000, v18
    v_mul_f32 v17, s37, v18
    s_mov_b32 s38, 0
L_v:
    ds_read_b128 v[136:139], v16
    ds_read_b128 v[36:39], v15 offset:0
    ds_read_b128 v[40:43], v15 offset:640
    ds_read_b128 v[44:47], v15 offset:64
    ds_read_b128 v[48:51], v15 offset:704
    s_add_u32 s38, s38, 1
    s_add_u32 s40, s40, 8388608
    s_cmp_eq_u32 s38, 4
    s_cselect_b32 s40, s65, s40
    s_add_u32 s41, s40, 4096
    s_add_u32 s42, s40, 4194304
    s_add_u32 s43, s40, 4198400
    s_waitcnt lgkmcnt(4)
    v_lshlrev_b32 v52, 16, v136
    v_and_b32 v53, 0xffff0000, v136
    v_lshlrev_b32 v54, 16, v137
    v_and_b32 v55, 0xffff0000, v137
    v_lshlrev_b32 v56, 16, v138
    v_and_b32 v57, 0xffff0000, v138
    v_lshlrev_b32 v58, 16, v139
    v_and_b32 v59, 0xffff0000, v139
    v_fma_f32 v52, v52, s37, -v17
    v_fma_f32 v53, v53, s37, -v17
    v_fma_f32 v54, v54, s37, -v17
    v_fma_f32 v55, v55, s37, -v17
    v_fma_f32 v56, v56, s37, -v17
    v_fma_f32 v57, v57, s37, -v17
    v_fma_f32 v58, v58, s37, -v17
    v_fma_f32 v59, v59, s37, -v17
    v_exp_f32 v52, v52
    v_exp_f32 v53, v53
    v_exp_f32 v54, v54
    v_exp_f32 v55, v55
    v_exp_f32 v56, v56
    v_exp_f32 v57, v57
    v_exp_f32 v58, v58
    v_exp_f32 v59, v59
    s_nop 0
    v_cvt_pk_bf16_f32 v132, v52, v53
    v_cvt_pk_bf16_f32 v133, v54, v55
    v_cvt_pk_bf16_f32 v134, v56, v57
    v_cvt_pk_bf16_f32 v135, v58, v59
    v_add_f32 v52, v52, v53
    v_add_f32 v54, v54, v55
    v_add_f32 v56, v56, v57
    v_add_f32 v58, v58, v59
    v_add_f32 v52, v52, v54
    v_add_f32 v56, v56, v58
    v_add_f32 v52, v52, v56
    v_add_f32 v19, v19, v52
    s_waitcnt vmcnt(15)
    v_cvt_f32_i32 v140, v156
    v_cvt_f32_i32 v141, v157
    v_cvt_f32_i32 v142, v158
    v_cvt_f32_i32 v143, v159
    buffer_load_dwordx4 v[156:159], v1, s[12:15], s40 offen offset:0 nt
    s_waitcnt lgkmcnt(0)
    v_pk_add_f32 v[140:141], v[140:141], v[36:37] op_sel:[0,0] op_sel_hi:[1,0] neg_lo:[0,1] neg_hi:[0,1]
    v_pk_add_f32 v[142:143], v[142:143], v[36:37] op_sel:[0,0] op_sel_hi:[1,0] neg_lo:[0,1] neg_hi:[0,1]
    v_cvt_pk_bf16_f32 v154, v140, v141
    v_cvt_pk_bf16_f32 v155, v142, v143
    v_lshlrev_b32 v140, 16, v154
    v_and_b32 v141, 0xffff0000, v154
    v_lshlrev_b32 v142, 16, v155
    v_and_b32 v143, 0xffff0000, v155
    v_pk_mul_f32 v[140:141], v[140:141], v[40:41] op_sel:[0,0] op_sel_hi:[1,0]
    v_pk_mul_f32 v[142:143], v[142:143], v[40:41] op_sel:[0,0] op_sel_hi:[1,0]
    s_waitcnt vmcnt(15)
    v_cvt_f32_i32 v144, v160
    v_cvt_f32_i32 v145, v161
    v_cvt_f32_i32 v146, v162
    v_cvt_f32_i32 v147, v163
    buffer_load_dwordx4 v[160:163], v1, s[12:15], s40 offen offset:2048 nt
    v_pk_add_f32 v[144:145], v[144:145], v[36:37] op_sel:[0,1] op_sel_hi:[1,1] neg_lo:[0,1] neg_hi:[0,1]
    v_pk_add_f32 v[146:147], v[146:147], v[36:37] op_sel:[0,1] op_sel_hi:[1,1] neg_lo:[0,1] neg_hi:[0,1]
    v_cvt_pk_bf16_f32 v154, v144, v145
    v_cvt_pk_bf16_f32 v155, v146, v147
    v_lshlrev_b32 v144, 16, v154
    v_and_b32 v145, 0xffff0000, v154
    v_lshlrev_b32 v146, 16, v155
    v_and_b32 v147, 0xffff0000, v155
    v_pk_mul_f32 v[144:145], v[144:145], v[40:41] op_sel:[0,1] op_sel_hi:[1,1]
    v_pk_mul_f32 v[146:147], v[146:147], v[40:41] op_sel:[0,1] op_sel_hi:[1,1]
    v_cvt_pk_bf16_f32 v100, v140, v144
    v_cvt_pk_bf16_f32 v104, v141, v145
    v_cvt_pk_bf16_f32 v108, v142, v146
    v_cvt_pk_bf16_f32 v112, v143, v147
    s_waitcnt vmcnt(15)
    v_cvt_f32_i32 v140, v164
    v_cvt_f32_i32 v141, v165
    v_cvt_f32_i32 v142, v166
    v_cvt_f32_i32 v143, v167
    buffer_load_dwordx4 v[164:167], v1, s[12:15], s40 offen offset:256 nt
    v_pk_add_f32 v[140:141], v[140:141], v[36:37] op_sel:[0,0] op_sel_hi:[1,0] neg_lo:[0,1] neg_hi:[0,1]
    v_pk_add_f32 v[142:143], v[142:143], v[36:37] op_sel:[0,0] op_sel_hi:[1,0] neg_lo:[0,1] neg_hi:[0,1]
    v_cvt_pk_bf16_f32 v154, v140, v141
    v_cvt_pk_bf16_f32 v155, v142, v143
    v_lshlrev_b32 v140, 16, v154
    v_and_b32 v141, 0xffff0000, v154
    v_lshlrev_b32 v142, 16, v155
    v_and_b32 v143, 0xffff0000, v155
    v_pk_mul_f32 v[140:141], v[140:141], v[40:41] op_sel:[0,0] op_sel_hi:[1,0]
    v_pk_mul_f32 v[142:143], v[142:143], v[40:41] op_sel:[0,0] op_sel_hi:[1,0]
    s_waitcnt vmcnt(15)
    v_cvt_f32_i32 v144, v168
    v_cvt_f32_i32 v145, v169
    v_cvt_f32_i32 v146, v170
    v_cvt_f32_i32 v147, v171
    buffer_load_dwordx4 v[168:171], v1, s[12:15], s40 offen offset:2304 nt
    v_pk_add_f32 v[144:145], v[144:145], v[36:37] op_sel:[0,1] op_sel_hi:[1,1] neg_lo:[0,1] neg_hi:[0,1]
    v_pk_add_f32 v[146:147], v[146:147], v[36:37] op_sel:[0,1] op_sel_hi:[1,1] neg_lo:[0,1] neg_hi:[0,1]
    v_cvt_pk_bf16_f32 v154, v144, v145
    v_cvt_pk_bf16_f32 v155, v146, v147
    v_lshlrev_b32 v144, 16, v154
    v_and_b32 v145, 0xffff0000, v154
    v_lshlrev_b32 v146, 16, v155
    v_and_b32 v147, 0xffff0000, v155
    v_pk_mul_f32 v[144:145], v[144:145], v[40:41] op_sel:[0,1] op_sel_hi:[1,1]
    v_pk_mul_f32 v[146:147], v[146:147], v[40:41] op_sel:[0,1] op_sel_hi:[1,1]
    v_cvt_pk_bf16_f32 v116, v140, v144
    v_cvt_pk_bf16_f32 v120, v141, v145
    v_cvt_pk_bf16_f32 v124, v142, v146
    v_cvt_pk_bf16_f32 v128, v143, v147
    s_waitcnt vmcnt(15)
    v_cvt_f32_i32 v140, v172
    v_cvt_f32_i32 v141, v173
    v_cvt_f32_i32 v142, v174
    v_cvt_f32_i32 v143, v175
    buffer_load_dwordx4 v[172:175], v1, s[12:15], s41 offen offset:0 nt
    v_pk_add_f32 v[140:141], v[140:141], v[38:39] op_sel:[0,0] op_sel_hi:[1,0] neg_lo:[0,1] neg_hi:[0,1]
    v_pk_add_f32 v[142:143], v[142:143], v[38:39] op_sel:[0,0] op_sel_hi:[1,0] neg_lo:[0,1] neg_hi:[0,1]
    v_cvt_pk_bf16_f32 v154, v140, v141
    v_cvt_pk_bf16_f32 v155, v142, v143
    v_lshlrev_b32 v140, 16, v154
    v_and_b32 v141, 0xffff0000, v154
    v_lshlrev_b32 v142, 16, v155
    v_and_b32 v143, 0xffff0000, v155
    v_pk_mul_f32 v[140:141], v[140:141], v[42:43] op_sel:[0,0] op_sel_hi:[1,0]
    v_pk_mul_f32 v[142:143], v[142:143], v[42:43] op_sel:[0,0] op_sel_hi:[1,0]
    s_waitcnt vmcnt(15)
    v_cvt_f32_i32 v144, v176
    v_cvt_f32_i32 v145, v177
    v_cvt_f32_i32 v146, v178
    v_cvt_f32_i32 v147, v179
    buffer_load_dwordx4 v[176:179], v1, s[12:15], s41 offen offset:2048 nt
    v_pk_add_f32 v[144:145], v[144:145], v[38:39] op_sel:[0,1] op_sel_hi:[1,1] neg_lo:[0,1] neg_hi:[0,1]
    v_pk_add_f32 v[146:147], v[146:147], v[38:39] op_sel:[0,1] op_sel_hi:[1,1] neg_lo:[0,1] neg_hi:[0,1]
    v_cvt_pk_bf16_f32 v154, v144, v145
    v_cvt_pk_bf16_f32 v155, v146, v147
    v_lshlrev_b32 v144, 16, v154
    v_and_b32 v145, 0xffff0000, v154
    v_lshlrev_b32 v146, 16, v155
    v_and_b32 v147, 0xffff0000, v155
    v_pk_mul_f32 v[144:145], v[144:145], v[42:43] op_sel:[0,1] op_sel_hi:[1,1]
    v_pk_mul_f32 v[146:147], v[146:147], v[42:43] op_sel:[0,1] op_sel_hi:[1,1]
    v_cvt_pk_bf16_f32 v101, v140, v144
    v_cvt_pk_bf16_f32 v105, v141, v145
    v_cvt_pk_bf16_f32 v109, v142, v146
    v_cvt_pk_bf16_f32 v113, v143, v147
    s_waitcnt vmcnt(15)
    v_cvt_f32_i32 v140, v180
    v_cvt_f32_i32 v141, v181
    v_cvt_f32_i32 v142, v182
    v_cvt_f32_i32 v143, v183
    buffer_load_dwordx4 v[180:183], v1, s[12:15], s41 offen offset:256 nt
    v_pk_add_f32 v[140:141], v[140:141], v[38:39] op_sel:[0,0] op_sel_hi:[1,0] neg_lo:[0,1] neg_hi:[0,1]
    v_pk_add_f32 v[142:143], v[142:143], v[38:39] op_sel:[0,0] op_sel_hi:[1,0] neg_lo:[0,1] neg_hi:[0,1]
    v_cvt_pk_bf16_f32 v154, v140, v141
    v_cvt_pk_bf16_f32 v155, v142, v143
    v_lshlrev_b32 v140, 16, v154
    v_and_b32 v141, 0xffff0000, v154
    v_lshlrev_b32 v142, 16, v155
    v_and_b32 v143, 0xffff0000, v155
    v_pk_mul_f32 v[140:141], v[140:141], v[42:43] op_sel:[0,0] op_sel_hi:[1,0]
    v_pk_mul_f32 v[142:143], v[142:143], v[42:43] op_sel:[0,0] op_sel_hi:[1,0]
    s_waitcnt vmcnt(15)
    v_cvt_f32_i32 v144, v184
    v_cvt_f32_i32 v145, v185
    v_cvt_f32_i32 v146, v186
    v_cvt_f32_i32 v147, v187
    buffer_load_dwordx4 v[184:187], v1, s[12:15], s41 offen offset:2304 nt
    v_pk_add_f32 v[144:145], v[144:145], v[38:39] op_sel:[0,1] op_sel_hi:[1,1] neg_lo:[0,1] neg_hi:[0,1]
    v_pk_add_f32 v[146:147], v[146:147], v[38:39] op_sel:[0,1] op_sel_hi:[1,1] neg_lo:[0,1] neg_hi:[0,1]
    v_cvt_pk_bf16_f32 v154, v144, v145
    v_cvt_pk_bf16_f32 v155, v146, v147
    v_lshlrev_b32 v144, 16, v154
    v_and_b32 v145, 0xffff0000, v154
    v_lshlrev_b32 v146, 16, v155
    v_and_b32 v147, 0xffff0000, v155
    v_pk_mul_f32 v[144:145], v[144:145], v[42:43] op_sel:[0,1] op_sel_hi:[1,1]
    v_pk_mul_f32 v[146:147], v[146:147], v[42:43] op_sel:[0,1] op_sel_hi:[1,1]
    v_cvt_pk_bf16_f32 v117, v140, v144
    v_cvt_pk_bf16_f32 v121, v141, v145
    v_cvt_pk_bf16_f32 v125, v142, v146
    v_cvt_pk_bf16_f32 v129, v143, v147
    s_waitcnt vmcnt(15)
    v_cvt_f32_i32 v140, v188
    v_cvt_f32_i32 v141, v189
    v_cvt_f32_i32 v142, v190
    v_cvt_f32_i32 v143, v191
    buffer_load_dwordx4 v[188:191], v1, s[12:15], s42 offen offset:0 nt
    v_pk_add_f32 v[140:141], v[140:141], v[44:45] op_sel:[0,0] op_sel_hi:[1,0] neg_lo:[0,1] neg_hi:[0,1]
    v_pk_add_f32 v[142:143], v[142:143], v[44:45] op_sel:[0,0] op_sel_hi:[1,0] neg_lo:[0,1] neg_hi:[0,1]
    v_cvt_pk_bf16_f32 v154, v140, v141
    v_cvt_pk_bf16_f32 v155, v142, v143
    v_lshlrev_b32 v140, 16, v154
    v_and_b32 v141, 0xffff0000, v154
    v_lshlrev_b32 v142, 16, v155
    v_and_b32 v143, 0xffff0000, v155
    v_pk_mul_f32 v[140:141], v[140:141], v[48:49] op_sel:[0,0] op_sel_hi:[1,0]
    v_pk_mul_f32 v[142:143], v[142:143], v[48:49] op_sel:[0,0] op_sel_hi:[1,0]
    s_waitcnt vmcnt(15)
    v_cvt_f32_i32 v144, v192
    v_cvt_f32_i32 v145, v193
    v_cvt_f32_i32 v146, v194
    v_cvt_f32_i32 v147, v195
    buffer_load_dwordx4 v[192:195], v1, s[12:15], s42 offen offset:2048 nt
    v_pk_add_f32 v[144:145], v[144:145], v[44:45] op_sel:[0,1] op_sel_hi:[1,1] neg_lo:[0,1] neg_hi:[0,1]
    v_pk_add_f32 v[146:147], v[146:147], v[44:45] op_sel:[0,1] op_sel_hi:[1,1] neg_lo:[0,1] neg_hi:[0,1]
    v_cvt_pk_bf16_f32 v154, v144, v145
    v_cvt_pk_bf16_f32 v155, v146, v147
    v_lshlrev_b32 v144, 16, v154
    v_and_b32 v145, 0xffff0000, v154
    v_lshlrev_b32 v146, 16, v155
    v_and_b32 v147, 0xffff0000, v155
    v_pk_mul_f32 v[144:145], v[144:145], v[48:49] op_sel:[0,1] op_sel_hi:[1,1]
    v_pk_mul_f32 v[146:147], v[146:147], v[48:49] op_sel:[0,1] op_sel_hi:[1,1]
    v_cvt_pk_bf16_f32 v102, v140, v144
    v_cvt_pk_bf16_f32 v106, v141, v145
    v_cvt_pk_bf16_f32 v110, v142, v146
    v_cvt_pk_bf16_f32 v114, v143, v147
    s_waitcnt vmcnt(15)
    v_cvt_f32_i32 v140, v196
    v_cvt_f32_i32 v141, v197
    v_cvt_f32_i32 v142, v198
    v_cvt_f32_i32 v143, v199
    buffer_load_dwordx4 v[196:199], v1, s[12:15], s42 offen offset:256 nt
    v_pk_add_f32 v[140:141], v[140:141], v[44:45] op_sel:[0,0] op_sel_hi:[1,0] neg_lo:[0,1] neg_hi:[0,1]
    v_pk_add_f32 v[142:143], v[142:143], v[44:45] op_sel:[0,0] op_sel_hi:[1,0] neg_lo:[0,1] neg_hi:[0,1]
    v_cvt_pk_bf16_f32 v154, v140, v141
    v_cvt_pk_bf16_f32 v155, v142, v143
    v_lshlrev_b32 v140, 16, v154
    v_and_b32 v141, 0xffff0000, v154
    v_lshlrev_b32 v142, 16, v155
    v_and_b32 v143, 0xffff0000, v155
    v_pk_mul_f32 v[140:141], v[140:141], v[48:49] op_sel:[0,0] op_sel_hi:[1,0]
    v_pk_mul_f32 v[142:143], v[142:143], v[48:49] op_sel:[0,0] op_sel_hi:[1,0]
    s_waitcnt vmcnt(15)
    v_cvt_f32_i32 v144, v200
    v_cvt_f32_i32 v145, v201
    v_cvt_f32_i32 v146, v202
    v_cvt_f32_i32 v147, v203
    buffer_load_dwordx4 v[200:203], v1, s[12:15], s42 offen offset:2304 nt
    v_pk_add_f32 v[144:145], v[144:145], v[44:45] op_sel:[0,1] op_sel_hi:[1,1] neg_lo:[0,1] neg_hi:[0,1]
    v_pk_add_f32 v[146:147], v[146:147], v[44:45] op_sel:[0,1] op_sel_hi:[1,1] neg_lo:[0,1] neg_hi:[0,1]
    v_cvt_pk_bf16_f32 v154, v144, v145
    v_cvt_pk_bf16_f32 v155, v146, v147
    v_lshlrev_b32 v144, 16, v154
    v_and_b32 v145, 0xffff0000, v154
    v_lshlrev_b32 v146, 16, v155
    v_and_b32 v147, 0xffff0000, v155
    v_pk_mul_f32 v[144:145], v[144:145], v[48:49] op_sel:[0,1] op_sel_hi:[1,1]
    v_pk_mul_f32 v[146:147], v[146:147], v[48:49] op_sel:[0,1] op_sel_hi:[1,1]
    v_cvt_pk_bf16_f32 v118, v140, v144
    v_cvt_pk_bf16_f32 v122, v141, v145
    v_cvt_pk_bf16_f32 v126, v142, v146
    v_cvt_pk_bf16_f32 v130, v143, v147
    s_waitcnt vmcnt(15)
    v_cvt_f32_i32 v140, v204
    v_cvt_f32_i32 v141, v205
    v_cvt_f32_i32 v142, v206
    v_cvt_f32_i32 v143, v207
    buffer_load_dwordx4 v[204:207], v1, s[12:15], s43 offen offset:0 nt
    v_pk_add_f32 v[140:141], v[140:141], v[46:47] op_sel:[0,0] op_sel_hi:[1,0] neg_lo:[0,1] neg_hi:[0,1]
    v_pk_add_f32 v[142:143], v[142:143], v[46:47] op_sel:[0,0] op_sel_hi:[1,0] neg_lo:[0,1] neg_hi:[0,1]
    v_cvt_pk_bf16_f32 v154, v140, v141
    v_cvt_pk_bf16_f32 v155, v142, v143
    v_lshlrev_b32 v140, 16, v154
    v_and_b32 v141, 0xffff0000, v154
    v_lshlrev_b32 v142, 16, v155
    v_and_b32 v143, 0xffff0000, v155
    v_pk_mul_f32 v[140:141], v[140:141], v[50:51] op_sel:[0,0] op_sel_hi:[1,0]
    v_pk_mul_f32 v[142:143], v[142:143], v[50:51] op_sel:[0,0] op_sel_hi:[1,0]
    s_waitcnt vmcnt(15)
    v_cvt_f32_i32 v144, v208
    v_cvt_f32_i32 v145, v209
    v_cvt_f32_i32 v146, v210
    v_cvt_f32_i32 v147, v211
    buffer_load_dwordx4 v[208:211], v1, s[12:15], s43 offen offset:2048 nt
    v_pk_add_f32 v[144:145], v[144:145], v[46:47] op_sel:[0,1] op_sel_hi:[1,1] neg_lo:[0,1] neg_hi:[0,1]
    v_pk_add_f32 v[146:147], v[146:147], v[46:47] op_sel:[0,1] op_sel_hi:[1,1] neg_lo:[0,1] neg_hi:[0,1]
    v_cvt_pk_bf16_f32 v154, v144, v145
    v_cvt_pk_bf16_f32 v155, v146, v147
    v_lshlrev_b32 v144, 16, v154
    v_and_b32 v145, 0xffff0000, v154
    v_lshlrev_b32 v146, 16, v155
    v_and_b32 v147, 0xffff0000, v155
    v_pk_mul_f32 v[144:145], v[144:145], v[50:51] op_sel:[0,1] op_sel_hi:[1,1]
    v_pk_mul_f32 v[146:147], v[146:147], v[50:51] op_sel:[0,1] op_sel_hi:[1,1]
    v_cvt_pk_bf16_f32 v103, v140, v144
    v_cvt_pk_bf16_f32 v107, v141, v145
    v_cvt_pk_bf16_f32 v111, v142, v146
    v_cvt_pk_bf16_f32 v115, v143, v147
    s_nop 1
    v_mfma_f32_16x16x32_bf16 v[68:71], v[100:103], v[132:135], v[68:71]
    v_mfma_f32_16x16x32_bf16 v[72:75], v[104:107], v[132:135], v[72:75]
    v_mfma_f32_16x16x32_bf16 v[76:79], v[108:111], v[132:135], v[76:79]
    v_mfma_f32_16x16x32_bf16 v[80:83], v[112:115], v[132:135], v[80:83]
    s_waitcnt vmcnt(15)
    v_cvt_f32_i32 v140, v212
    v_cvt_f32_i32 v141, v213
    v_cvt_f32_i32 v142, v214
    v_cvt_f32_i32 v143, v215
    buffer_load_dwordx4 v[212:215], v1, s[12:15], s43 offen offset:256 nt
    v_pk_add_f32 v[140:141], v[140:141], v[46:47] op_sel:[0,0] op_sel_hi:[1,0] neg_lo:[0,1] neg_hi:[0,1]
    v_pk_add_f32 v[142:143], v[142:143], v[46:47] op_sel:[0,0] op_sel_hi:[1,0] neg_lo:[0,1] neg_hi:[0,1]
    v_cvt_pk_bf16_f32 v154, v140, v141
    v_cvt_pk_bf16_f32 v155, v142, v143
    v_lshlrev_b32 v140, 16, v154
    v_and_b32 v141, 0xffff0000, v154
    v_lshlrev_b32 v142, 16, v155
    v_and_b32 v143, 0xffff0000, v155
    v_pk_mul_f32 v[140:141], v[140:141], v[50:51] op_sel:[0,0] op_sel_hi:[1,0]
    v_pk_mul_f32 v[142:143], v[142:143], v[50:51] op_sel:[0,0] op_sel_hi:[1,0]
    s_waitcnt vmcnt(15)
    v_cvt_f32_i32 v144, v216
    v_cvt_f32_i32 v145, v217
    v_cvt_f32_i32 v146, v218
    v_cvt_f32_i32 v147, v219
    buffer_load_dwordx4 v[216:219], v1, s[12:15], s43 offen offset:2304 nt
    v_pk_add_f32 v[144:145], v[144:145], v[46:47] op_sel:[0,1] op_sel_hi:[1,1] neg_lo:[0,1] neg_hi:[0,1]
    v_pk_add_f32 v[146:147], v[146:147], v[46:47] op_sel:[0,1] op_sel_hi:[1,1] neg_lo:[0,1] neg_hi:[0,1]
    v_cvt_pk_bf16_f32 v154, v144, v145
    v_cvt_pk_bf16_f32 v155, v146, v147
    v_lshlrev_b32 v144, 16, v154
    v_and_b32 v145, 0xffff0000, v154
    v_lshlrev_b32 v146, 16, v155
    v_and_b32 v147, 0xffff0000, v155
    v_pk_mul_f32 v[144:145], v[144:145], v[50:51] op_sel:[0,1] op_sel_hi:[1,1]
    v_pk_mul_f32 v[146:147], v[146:147], v[50:51] op_sel:[0,1] op_sel_hi:[1,1]
    v_cvt_pk_bf16_f32 v119, v140, v144
    v_cvt_pk_bf16_f32 v123, v141, v145
    v_cvt_pk_bf16_f32 v127, v142, v146
    v_cvt_pk_bf16_f32 v131, v143, v147
    s_nop 1
    v_mfma_f32_16x16x32_bf16 v[84:87], v[116:119], v[132:135], v[84:87]
    v_mfma_f32_16x16x32_bf16 v[88:91], v[120:123], v[132:135], v[88:91]
    v_mfma_f32_16x16x32_bf16 v[92:95], v[124:127], v[132:135], v[92:95]
    v_mfma_f32_16x16x32_bf16 v[96:99], v[128:131], v[132:135], v[96:99]
    v_add_u32 v16, 1024, v16
    v_add_u32 v15, 128, v15
    s_cmp_lt_u32 s38, s64
    s_cbranch_scc1 L_v
    ds_read_b128 v[136:139], v16
    ds_read_b128 v[36:39], v15 offset:0
    ds_read_b128 v[40:43], v15 offset:640
    ds_read_b128 v[44:47], v15 offset:64
    ds_read_b128 v[48:51], v15 offset:704
    s_waitcnt lgkmcnt(4)
    v_lshlrev_b32 v52, 16, v136
    v_and_b32 v53, 0xffff0000, v136
    v_lshlrev_b32 v54, 16, v137
    v_and_b32 v55, 0xffff0000, v137
    v_lshlrev_b32 v56, 16, v138
    v_and_b32 v57, 0xffff0000, v138
    v_lshlrev_b32 v58, 16, v139
    v_and_b32 v59, 0xffff0000, v139
    v_fma_f32 v52, v52, s37, -v17
    v_fma_f32 v53, v53, s37, -v17
    v_fma_f32 v54, v54, s37, -v17
    v_fma_f32 v55, v55, s37, -v17
    v_fma_f32 v56, v56, s37, -v17
    v_fma_f32 v57, v57, s37, -v17
    v_fma_f32 v58, v58, s37, -v17
    v_fma_f32 v59, v59, s37, -v17
    v_exp_f32 v52, v52
    v_exp_f32 v53, v53
    v_exp_f32 v54, v54
    v_exp_f32 v55, v55
    v_exp_f32 v56, v56
    v_exp_f32 v57, v57
    v_exp_f32 v58, v58
    v_exp_f32 v59, v59
    s_nop 0
    v_cvt_pk_bf16_f32 v132, v52, v53
    v_cvt_pk_bf16_f32 v133, v54, v55
    v_cvt_pk_bf16_f32 v134, v56, v57
    v_cvt_pk_bf16_f32 v135, v58, v59
    v_add_f32 v52, v52, v53
    v_add_f32 v54, v54, v55
    v_add_f32 v56, v56, v57
    v_add_f32 v58, v58, v59
    v_add_f32 v52, v52, v54
    v_add_f32 v56, v56, v58
    v_add_f32 v52, v52, v56
    v_add_f32 v19, v19, v52
    s_waitcnt vmcnt(15)
    v_cvt_f32_i32 v140, v156
    v_cvt_f32_i32 v141, v157
    v_cvt_f32_i32 v142, v158
    v_cvt_f32_i32 v143, v159
    s_waitcnt lgkmcnt(0)
    v_pk_add_f32 v[140:141], v[140:141], v[36:37] op_sel:[0,0] op_sel_hi:[1,0] neg_lo:[0,1] neg_hi:[0,1]
    v_pk_add_f32 v[142:143], v[142:143], v[36:37] op_sel:[0,0] op_sel_hi:[1,0] neg_lo:[0,1] neg_hi:[0,1]
    v_cvt_pk_bf16_f32 v154, v140, v141
    v_cvt_pk_bf16_f32 v155, v142, v143
    v_lshlrev_b32 v140, 16, v154
    v_and_b32 v141, 0xffff0000, v154
    v_lshlrev_b32 v142, 16, v155
    v_and_b32 v143, 0xffff0000, v155
    v_pk_mul_f32 v[140:141], v[140:141], v[40:41] op_sel:[0,0] op_sel_hi:[1,0]
    v_pk_mul_f32 v[142:143], v[142:143], v[40:41] op_sel:[0,0] op_sel_hi:[1,0]
    s_waitcnt vmcnt(14)
    v_cvt_f32_i32 v144, v160
    v_cvt_f32_i32 v145, v161
    v_cvt_f32_i32 v146, v162
    v_cvt_f32_i32 v147, v163
    v_pk_add_f32 v[144:145], v[144:145], v[36:37] op_sel:[0,1] op_sel_hi:[1,1] neg_lo:[0,1] neg_hi:[0,1]
    v_pk_add_f32 v[146:147], v[146:147], v[36:37] op_sel:[0,1] op_sel_hi:[1,1] neg_lo:[0,1] neg_hi:[0,1]
    v_cvt_pk_bf16_f32 v154, v144, v145
    v_cvt_pk_bf16_f32 v155, v146, v147
    v_lshlrev_b32 v144, 16, v154
    v_and_b32 v145, 0xffff0000, v154
    v_lshlrev_b32 v146, 16, v155
    v_and_b32 v147, 0xffff0000, v155
    v_pk_mul_f32 v[144:145], v[144:145], v[40:41] op_sel:[0,1] op_sel_hi:[1,1]
    v_pk_mul_f32 v[146:147], v[146:147], v[40:41] op_sel:[0,1] op_sel_hi:[1,1]
    v_cvt_pk_bf16_f32 v100, v140, v144
    v_cvt_pk_bf16_f32 v104, v141, v145
    v_cvt_pk_bf16_f32 v108, v142, v146
    v_cvt_pk_bf16_f32 v112, v143, v147
    s_waitcnt vmcnt(13)
    v_cvt_f32_i32 v140, v164
    v_cvt_f32_i32 v141, v165
    v_cvt_f32_i32 v142, v166
    v_cvt_f32_i32 v143, v167
    v_pk_add_f32 v[140:141], v[140:141], v[36:37] op_sel:[0,0] op_sel_hi:[1,0] neg_lo:[0,1] neg_hi:[0,1]
    v_pk_add_f32 v[142:143], v[142:143], v[36:37] op_sel:[0,0] op_sel_hi:[1,0] neg_lo:[0,1] neg_hi:[0,1]
    v_cvt_pk_bf16_f32 v154, v140, v141
    v_cvt_pk_bf16_f32 v155, v142, v143
    v_lshlrev_b32 v140, 16, v154
    v_and_b32 v141, 0xffff0000, v154
    v_lshlrev_b32 v142, 16, v155
    v_and_b32 v143, 0xffff0000, v155
    v_pk_mul_f32 v[140:141], v[140:141], v[40:41] op_sel:[0,0] op_sel_hi:[1,0]
    v_pk_mul_f32 v[142:143], v[142:143], v[40:41] op_sel:[0,0] op_sel_hi:[1,0]
    s_waitcnt vmcnt(12)
    v_cvt_f32_i32 v144, v168
    v_cvt_f32_i32 v145, v169
    v_cvt_f32_i32 v146, v170
    v_cvt_f32_i32 v147, v171
    v_pk_add_f32 v[144:145], v[144:145], v[36:37] op_sel:[0,1] op_sel_hi:[1,1] neg_lo:[0,1] neg_hi:[0,1]
    v_pk_add_f32 v[146:147], v[146:147], v[36:37] op_sel:[0,1] op_sel_hi:[1,1] neg_lo:[0,1] neg_hi:[0,1]
    v_cvt_pk_bf16_f32 v154, v144, v145
    v_cvt_pk_bf16_f32 v155, v146, v147
    v_lshlrev_b32 v144, 16, v154
    v_and_b32 v145, 0xffff0000, v154
    v_lshlrev_b32 v146, 16, v155
    v_and_b32 v147, 0xffff0000, v155
    v_pk_mul_f32 v[144:145], v[144:145], v[40:41] op_sel:[0,1] op_sel_hi:[1,1]
    v_pk_mul_f32 v[146:147], v[146:147], v[40:41] op_sel:[0,1] op_sel_hi:[1,1]
    v_cvt_pk_bf16_f32 v116, v140, v144
    v_cvt_pk_bf16_f32 v120, v141, v145
    v_cvt_pk_bf16_f32 v124, v142, v146
    v_cvt_pk_bf16_f32 v128, v143, v147
    s_waitcnt vmcnt(11)
    v_cvt_f32_i32 v140, v172
    v_cvt_f32_i32 v141, v173
    v_cvt_f32_i32 v142, v174
    v_cvt_f32_i32 v143, v175
    v_pk_add_f32 v[140:141], v[140:141], v[38:39] op_sel:[0,0] op_sel_hi:[1,0] neg_lo:[0,1] neg_hi:[0,1]
    v_pk_add_f32 v[142:143], v[142:143], v[38:39] op_sel:[0,0] op_sel_hi:[1,0] neg_lo:[0,1] neg_hi:[0,1]
    v_cvt_pk_bf16_f32 v154, v140, v141
    v_cvt_pk_bf16_f32 v155, v142, v143
    v_lshlrev_b32 v140, 16, v154
    v_and_b32 v141, 0xffff0000, v154
    v_lshlrev_b32 v142, 16, v155
    v_and_b32 v143, 0xffff0000, v155
    v_pk_mul_f32 v[140:141], v[140:141], v[42:43] op_sel:[0,0] op_sel_hi:[1,0]
    v_pk_mul_f32 v[142:143], v[142:143], v[42:43] op_sel:[0,0] op_sel_hi:[1,0]
    s_waitcnt vmcnt(10)
    v_cvt_f32_i32 v144, v176
    v_cvt_f32_i32 v145, v177
    v_cvt_f32_i32 v146, v178
    v_cvt_f32_i32 v147, v179
    v_pk_add_f32 v[144:145], v[144:145], v[38:39] op_sel:[0,1] op_sel_hi:[1,1] neg_lo:[0,1] neg_hi:[0,1]
    v_pk_add_f32 v[146:147], v[146:147], v[38:39] op_sel:[0,1] op_sel_hi:[1,1] neg_lo:[0,1] neg_hi:[0,1]
    v_cvt_pk_bf16_f32 v154, v144, v145
    v_cvt_pk_bf16_f32 v155, v146, v147
    v_lshlrev_b32 v144, 16, v154
    v_and_b32 v145, 0xffff0000, v154
    v_lshlrev_b32 v146, 16, v155
    v_and_b32 v147, 0xffff0000, v155
    v_pk_mul_f32 v[144:145], v[144:145], v[42:43] op_sel:[0,1] op_sel_hi:[1,1]
    v_pk_mul_f32 v[146:147], v[146:147], v[42:43] op_sel:[0,1] op_sel_hi:[1,1]
    v_cvt_pk_bf16_f32 v101, v140, v144
    v_cvt_pk_bf16_f32 v105, v141, v145
    v_cvt_pk_bf16_f32 v109, v142, v146
    v_cvt_pk_bf16_f32 v113, v143, v147
    s_waitcnt vmcnt(9)
    v_cvt_f32_i32 v140, v180
    v_cvt_f32_i32 v141, v181
    v_cvt_f32_i32 v142, v182
    v_cvt_f32_i32 v143, v183
    v_pk_add_f32 v[140:141], v[140:141], v[38:39] op_sel:[0,0] op_sel_hi:[1,0] neg_lo:[0,1] neg_hi:[0,1]
    v_pk_add_f32 v[142:143], v[142:143], v[38:39] op_sel:[0,0] op_sel_hi:[1,0] neg_lo:[0,1] neg_hi:[0,1]
    v_cvt_pk_bf16_f32 v154, v140, v141
    v_cvt_pk_bf16_f32 v155, v142, v143
    v_lshlrev_b32 v140, 16, v154
    v_and_b32 v141, 0xffff0000, v154
    v_lshlrev_b32 v142, 16, v155
    v_and_b32 v143, 0xffff0000, v155
    v_pk_mul_f32 v[140:141], v[140:141], v[42:43] op_sel:[0,0] op_sel_hi:[1,0]
    v_pk_mul_f32 v[142:143], v[142:143], v[42:43] op_sel:[0,0] op_sel_hi:[1,0]
    s_waitcnt vmcnt(8)
    v_cvt_f32_i32 v144, v184
    v_cvt_f32_i32 v145, v185
    v_cvt_f32_i32 v146, v186
    v_cvt_f32_i32 v147, v187
    v_pk_add_f32 v[144:145], v[144:145], v[38:39] op_sel:[0,1] op_sel_hi:[1,1] neg_lo:[0,1] neg_hi:[0,1]
    v_pk_add_f32 v[146:147], v[146:147], v[38:39] op_sel:[0,1] op_sel_hi:[1,1] neg_lo:[0,1] neg_hi:[0,1]
    v_cvt_pk_bf16_f32 v154, v144, v145
    v_cvt_pk_bf16_f32 v155, v146, v147
    v_lshlrev_b32 v144, 16, v154
    v_and_b32 v145, 0xffff0000, v154
    v_lshlrev_b32 v146, 16, v155
    v_and_b32 v147, 0xffff0000, v155
    v_pk_mul_f32 v[144:145], v[144:145], v[42:43] op_sel:[0,1] op_sel_hi:[1,1]
    v_pk_mul_f32 v[146:147], v[146:147], v[42:43] op_sel:[0,1] op_sel_hi:[1,1]
    v_cvt_pk_bf16_f32 v117, v140, v144
    v_cvt_pk_bf16_f32 v121, v141, v145
    v_cvt_pk_bf16_f32 v125, v142, v146
    v_cvt_pk_bf16_f32 v129, v143, v147
    s_waitcnt vmcnt(7)
    v_cvt_f32_i32 v140, v188
    v_cvt_f32_i32 v141, v189
    v_cvt_f32_i32 v142, v190
    v_cvt_f32_i32 v143, v191
    v_pk_add_f32 v[140:141], v[140:141], v[44:45] op_sel:[0,0] op_sel_hi:[1,0] neg_lo:[0,1] neg_hi:[0,1]
    v_pk_add_f32 v[142:143], v[142:143], v[44:45] op_sel:[0,0] op_sel_hi:[1,0] neg_lo:[0,1] neg_hi:[0,1]
    v_cvt_pk_bf16_f32 v154, v140, v141
    v_cvt_pk_bf16_f32 v155, v142, v143
    v_lshlrev_b32 v140, 16, v154
    v_and_b32 v141, 0xffff0000, v154
    v_lshlrev_b32 v142, 16, v155
    v_and_b32 v143, 0xffff0000, v155
    v_pk_mul_f32 v[140:141], v[140:141], v[48:49] op_sel:[0,0] op_sel_hi:[1,0]
    v_pk_mul_f32 v[142:143], v[142:143], v[48:49] op_sel:[0,0] op_sel_hi:[1,0]
    s_waitcnt vmcnt(6)
    v_cvt_f32_i32 v144, v192
    v_cvt_f32_i32 v145, v193
    v_cvt_f32_i32 v146, v194
    v_cvt_f32_i32 v147, v195
    v_pk_add_f32 v[144:145], v[144:145], v[44:45] op_sel:[0,1] op_sel_hi:[1,1] neg_lo:[0,1] neg_hi:[0,1]
    v_pk_add_f32 v[146:147], v[146:147], v[44:45] op_sel:[0,1] op_sel_hi:[1,1] neg_lo:[0,1] neg_hi:[0,1]
    v_cvt_pk_bf16_f32 v154, v144, v145
    v_cvt_pk_bf16_f32 v155, v146, v147
    v_lshlrev_b32 v144, 16, v154
    v_and_b32 v145, 0xffff0000, v154
    v_lshlrev_b32 v146, 16, v155
    v_and_b32 v147, 0xffff0000, v155
    v_pk_mul_f32 v[144:145], v[144:145], v[48:49] op_sel:[0,1] op_sel_hi:[1,1]
    v_pk_mul_f32 v[146:147], v[146:147], v[48:49] op_sel:[0,1] op_sel_hi:[1,1]
    v_cvt_pk_bf16_f32 v102, v140, v144
    v_cvt_pk_bf16_f32 v106, v141, v145
    v_cvt_pk_bf16_f32 v110, v142, v146
    v_cvt_pk_bf16_f32 v114, v143, v147
    s_waitcnt vmcnt(5)
    v_cvt_f32_i32 v140, v196
    v_cvt_f32_i32 v141, v197
    v_cvt_f32_i32 v142, v198
    v_cvt_f32_i32 v143, v199
    v_pk_add_f32 v[140:141], v[140:141], v[44:45] op_sel:[0,0] op_sel_hi:[1,0] neg_lo:[0,1] neg_hi:[0,1]
    v_pk_add_f32 v[142:143], v[142:143], v[44:45] op_sel:[0,0] op_sel_hi:[1,0] neg_lo:[0,1] neg_hi:[0,1]
    v_cvt_pk_bf16_f32 v154, v140, v141
    v_cvt_pk_bf16_f32 v155, v142, v143
    v_lshlrev_b32 v140, 16, v154
    v_and_b32 v141, 0xffff0000, v154
    v_lshlrev_b32 v142, 16, v155
    v_and_b32 v143, 0xffff0000, v155
    v_pk_mul_f32 v[140:141], v[140:141], v[48:49] op_sel:[0,0] op_sel_hi:[1,0]
    v_pk_mul_f32 v[142:143], v[142:143], v[48:49] op_sel:[0,0] op_sel_hi:[1,0]
    s_waitcnt vmcnt(4)
    v_cvt_f32_i32 v144, v200
    v_cvt_f32_i32 v145, v201
    v_cvt_f32_i32 v146, v202
    v_cvt_f32_i32 v147, v203
    v_pk_add_f32 v[144:145], v[144:145], v[44:45] op_sel:[0,1] op_sel_hi:[1,1] neg_lo:[0,1] neg_hi:[0,1]
    v_pk_add_f32 v[146:147], v[146:147], v[44:45] op_sel:[0,1] op_sel_hi:[1,1] neg_lo:[0,1] neg_hi:[0,1]
    v_cvt_pk_bf16_f32 v154, v144, v145
    v_cvt_pk_bf16_f32 v155, v146, v147
    v_lshlrev_b32 v144, 16, v154
    v_and_b32 v145, 0xffff0000, v154
    v_lshlrev_b32 v146, 16, v155
    v_and_b32 v147, 0xffff0000, v155
    v_pk_mul_f32 v[144:145], v[144:145], v[48:49] op_sel:[0,1] op_sel_hi:[1,1]
    v_pk_mul_f32 v[146:147], v[146:147], v[48:49] op_sel:[0,1] op_sel_hi:[1,1]
    v_cvt_pk_bf16_f32 v118, v140, v144
    v_cvt_pk_bf16_f32 v122, v141, v145
    v_cvt_pk_bf16_f32 v126, v142, v146
    v_cvt_pk_bf16_f32 v130, v143, v147
    s_waitcnt vmcnt(3)
    v_cvt_f32_i32 v140, v204
    v_cvt_f32_i32 v141, v205
    v_cvt_f32_i32 v142, v206
    v_cvt_f32_i32 v143, v207
    v_pk_add_f32 v[140:141], v[140:141], v[46:47] op_sel:[0,0] op_sel_hi:[1,0] neg_lo:[0,1] neg_hi:[0,1]
    v_pk_add_f32 v[142:143], v[142:143], v[46:47] op_sel:[0,0] op_sel_hi:[1,0] neg_lo:[0,1] neg_hi:[0,1]
    v_cvt_pk_bf16_f32 v154, v140, v141
    v_cvt_pk_bf16_f32 v155, v142, v143
    v_lshlrev_b32 v140, 16, v154
    v_and_b32 v141, 0xffff0000, v154
    v_lshlrev_b32 v142, 16, v155
    v_and_b32 v143, 0xffff0000, v155
    v_pk_mul_f32 v[140:141], v[140:141], v[50:51] op_sel:[0,0] op_sel_hi:[1,0]
    v_pk_mul_f32 v[142:143], v[142:143], v[50:51] op_sel:[0,0] op_sel_hi:[1,0]
    s_waitcnt vmcnt(2)
    v_cvt_f32_i32 v144, v208
    v_cvt_f32_i32 v145, v209
    v_cvt_f32_i32 v146, v210
    v_cvt_f32_i32 v147, v211
    v_pk_add_f32 v[144:145], v[144:145], v[46:47] op_sel:[0,1] op_sel_hi:[1,1] neg_lo:[0,1] neg_hi:[0,1]
    v_pk_add_f32 v[146:147], v[146:147], v[46:47] op_sel:[0,1] op_sel_hi:[1,1] neg_lo:[0,1] neg_hi:[0,1]
    v_cvt_pk_bf16_f32 v154, v144, v145
    v_cvt_pk_bf16_f32 v155, v146, v147
    v_lshlrev_b32 v144, 16, v154
    v_and_b32 v145, 0xffff0000, v154
    v_lshlrev_b32 v146, 16, v155
    v_and_b32 v147, 0xffff0000, v155
    v_pk_mul_f32 v[144:145], v[144:145], v[50:51] op_sel:[0,1] op_sel_hi:[1,1]
    v_pk_mul_f32 v[146:147], v[146:147], v[50:51] op_sel:[0,1] op_sel_hi:[1,1]
    v_cvt_pk_bf16_f32 v103, v140, v144
    v_cvt_pk_bf16_f32 v107, v141, v145
    v_cvt_pk_bf16_f32 v111, v142, v146
    v_cvt_pk_bf16_f32 v115, v143, v147
    s_nop 1
    v_mfma_f32_16x16x32_bf16 v[68:71], v[100:103], v[132:135], v[68:71]
    v_mfma_f32_16x16x32_bf16 v[72:75], v[104:107], v[132:135], v[72:75]
    v_mfma_f32_16x16x32_bf16 v[76:79], v[108:111], v[132:135], v[76:79]
    v_mfma_f32_16x16x32_bf16 v[80:83], v[112:115], v[132:135], v[80:83]
    s_waitcnt vmcnt(1)
    v_cvt_f32_i32 v140, v212
    v_cvt_f32_i32 v141, v213
    v_cvt_f32_i32 v142, v214
    v_cvt_f32_i32 v143, v215
    v_pk_add_f32 v[140:141], v[140:141], v[46:47] op_sel:[0,0] op_sel_hi:[1,0] neg_lo:[0,1] neg_hi:[0,1]
    v_pk_add_f32 v[142:143], v[142:143], v[46:47] op_sel:[0,0] op_sel_hi:[1,0] neg_lo:[0,1] neg_hi:[0,1]
    v_cvt_pk_bf16_f32 v154, v140, v141
    v_cvt_pk_bf16_f32 v155, v142, v143
    v_lshlrev_b32 v140, 16, v154
    v_and_b32 v141, 0xffff0000, v154
    v_lshlrev_b32 v142, 16, v155
    v_and_b32 v143, 0xffff0000, v155
    v_pk_mul_f32 v[140:141], v[140:141], v[50:51] op_sel:[0,0] op_sel_hi:[1,0]
    v_pk_mul_f32 v[142:143], v[142:143], v[50:51] op_sel:[0,0] op_sel_hi:[1,0]
    s_waitcnt vmcnt(0)
    v_cvt_f32_i32 v144, v216
    v_cvt_f32_i32 v145, v217
    v_cvt_f32_i32 v146, v218
    v_cvt_f32_i32 v147, v219
    v_pk_add_f32 v[144:145], v[144:145], v[46:47] op_sel:[0,1] op_sel_hi:[1,1] neg_lo:[0,1] neg_hi:[0,1]
    v_pk_add_f32 v[146:147], v[146:147], v[46:47] op_sel:[0,1] op_sel_hi:[1,1] neg_lo:[0,1] neg_hi:[0,1]
    v_cvt_pk_bf16_f32 v154, v144, v145
    v_cvt_pk_bf16_f32 v155, v146, v147
    v_lshlrev_b32 v144, 16, v154
    v_and_b32 v145, 0xffff0000, v154
    v_lshlrev_b32 v146, 16, v155
    v_and_b32 v147, 0xffff0000, v155
    v_pk_mul_f32 v[144:145], v[144:145], v[50:51] op_sel:[0,1] op_sel_hi:[1,1]
    v_pk_mul_f32 v[146:147], v[146:147], v[50:51] op_sel:[0,1] op_sel_hi:[1,1]
    v_cvt_pk_bf16_f32 v119, v140, v144
    v_cvt_pk_bf16_f32 v123, v141, v145
    v_cvt_pk_bf16_f32 v127, v142, v146
    v_cvt_pk_bf16_f32 v131, v143, v147
    s_nop 1
    v_mfma_f32_16x16x32_bf16 v[84:87], v[116:119], v[132:135], v[84:87]
    v_mfma_f32_16x16x32_bf16 v[88:91], v[120:123], v[132:135], v[88:91]
    v_mfma_f32_16x16x32_bf16 v[92:95], v[124:127], v[132:135], v[92:95]
    v_mfma_f32_16x16x32_bf16 v[96:99], v[128:131], v[132:135], v[96:99]
    s_nop 3
    v_mov_b32 v140, v19
    s_nop 1
    v_permlane32_swap_b32 v140, v19
    v_add_f32 v19, v19, v140
    v_mov_b32 v140, v19
    s_nop 1
    v_permlane16_swap_b32 v140, v19
    v_add_f32 v19, v19, v140
    v_and_b32 v4, 15, v0
    v_lshrrev_b32 v3, 4, v0
    v_mul_u32_u24 v5, 528, v4
    v_lshl_add_u32 v5, v3, 6, v5
    v_add_u32 v5, s32, v5
    v_lshlrev_b32 v6, 6, v4
    s_lshl_b32 s33, s3, 3
    s_add_u32 s33, s33, 157696
    v_add_u32 v6, s33, v6
    s_mov_b32 exec_lo, 0x00ff00ff
    s_mov_b32 exec_hi, 0x00ff00ff
    ds_write_b128 v5, v[68:71] offset:0
    ds_write_b128 v5, v[72:75] offset:16
    ds_write_b128 v5, v[76:79] offset:32
    ds_write_b128 v5, v[80:83] offset:48
    ds_write_b128 v5, v[84:87] offset:256
    ds_write_b128 v5, v[88:91] offset:272
    ds_write_b128 v5, v[92:95] offset:288
    ds_write_b128 v5, v[96:99] offset:304
    s_mov_b64 exec, 0xff
    ds_write_b64 v6, v[18:19]
    s_mov_b64 exec, -1
    s_lshl_b32 s33, s3, 1
    v_lshrrev_b32 v3, 5, v0
    v_add_u32 v3, s33, v3
    v_and_b32 v4, 31, v0
    v_mul_u32_u24 v5, 528, v3
    v_lshl_add_u32 v5, v4, 4, v5
    v_lshlrev_b32 v6, 6, v3
    v_add_u32 v6, 157696, v6
    s_mov_b32 s44, s30
    s_mov_b32 s45, s31
    s_mov_b32 s46, 0x200000
    s_mov_b32 s47, 0x20000
    s_lshl_b32 s33, s2, 12
    v_lshlrev_b32 v7, 9, v3
    v_lshl_add_u32 v7, v4, 4, v7
    s_lshl_b32 s34, s4, 12
    s_and_b32 s35, s2, 63
    s_lshl_b32 s35, s35, 3
    s_add_u32 s34, s34, s35
    s_add_u32 s34, s34, 0x100000
    v_lshlrev_b32 v8, 9, v3
    v_cmp_eq_u32 vcc, 0, v4
    s_waitcnt lgkmcnt(0)
    s_barrier
    s_cmp_ge_u32 s3, 4
    s_cbranch_scc1 L_fin
    ds_read_b128 v[20:23], v6 offset:0
    ds_read_b128 v[24:27], v6 offset:16
    ds_read_b128 v[28:31], v6 offset:32
    ds_read_b128 v[32:35], v6 offset:48
    ds_read_b128 v[40:43], v5 offset:0
    ds_read_b128 v[44:47], v5 offset:8192
    ds_read_b128 v[48:51], v5 offset:16384
    ds_read_b128 v[52:55], v5 offset:24576
    ds_read_b128 v[56:59], v5 offset:32768
    ds_read_b128 v[60:63], v5 offset:40960
    ds_read_b128 v[64:67], v5 offset:49152
    ds_read_b128 v[68:71], v5 offset:57344
    s_waitcnt lgkmcnt(8)
    v_max3_f32 v16, v20, v22, v24
    v_max3_f32 v9, v26, v28, v30
    v_max3_f32 v16, v16, v32, v34
    v_max_f32 v16, v16, v9
    v_sub_f32 v20, v20, v16
    v_sub_f32 v22, v22, v16
    v_sub_f32 v24, v24, v16
    v_sub_f32 v26, v26, v16
    v_sub_f32 v28, v28, v16
    v_sub_f32 v30, v30, v16
    v_sub_f32 v32, v32, v16
    v_sub_f32 v34, v34, v16
    v_mul_f32 v20, s37, v20
    v_mul_f32 v22, s37, v22
    v_mul_f32 v24, s37, v24
    v_mul_f32 v26, s37, v26
    v_mul_f32 v28, s37, v28
    v_mul_f32 v30, s37, v30
    v_mul_f32 v32, s37, v32
    v_mul_f32 v34, s37, v34
    v_exp_f32 v20, v20
    v_exp_f32 v22, v22
    v_exp_f32 v24, v24
    v_exp_f32 v26, v26
    v_exp_f32 v28, v28
    v_exp_f32 v30, v30
    v_exp_f32 v32, v32
    v_exp_f32 v34, v34
    s_waitcnt lgkmcnt(0)
    v_mul_f32 v12, v20, v40
    v_mul_f32 v13, v20, v41
    v_mul_f32 v14, v20, v42
    v_mul_f32 v15, v20, v43
    v_fmac_f32 v12, v22, v44
    v_fmac_f32 v13, v22, v45
    v_fmac_f32 v14, v22, v46
    v_fmac_f32 v15, v22, v47
    v_fmac_f32 v12, v24, v48
    v_fmac_f32 v13, v24, v49
    v_fmac_f32 v14, v24, v50
    v_fmac_f32 v15, v24, v51
    v_fmac_f32 v12, v26, v52
    v_fmac_f32 v13, v26, v53
    v_fmac_f32 v14, v26, v54
    v_fmac_f32 v15, v26, v55
    v_fmac_f32 v12, v28, v56
    v_fmac_f32 v13, v28, v57
    v_fmac_f32 v14, v28, v58
    v_fmac_f32 v15, v28, v59
    v_fmac_f32 v12, v30, v60
    v_fmac_f32 v13, v30, v61
    v_fmac_f32 v14, v30, v62
    v_fmac_f32 v15, v30, v63
    v_fmac_f32 v12, v32, v64
    v_fmac_f32 v13, v32, v65
    v_fmac_f32 v14, v32, v66
    v_fmac_f32 v15, v32, v67
    v_fmac_f32 v12, v34, v68
    v_fmac_f32 v13, v34, v69
    v_fmac_f32 v14, v34, v70
    v_fmac_f32 v15, v34, v71
    buffer_store_dwordx4 v[12:15], v7, s[44:47], s33 offen
    v_mul_f32 v17, v20, v21
    v_fmac_f32 v17, v22, v23
    v_fmac_f32 v17, v24, v25
    v_fmac_f32 v17, v26, v27
    v_fmac_f32 v17, v28, v29
    v_fmac_f32 v17, v30, v31
    v_fmac_f32 v17, v32, v33
    v_fmac_f32 v17, v34, v35
    s_mov_b64 exec, vcc
    buffer_store_dwordx2 v[16:17], v8, s[44:47], s34 offen
L_fin:
L_done:
    s_endpgm
.globl standalone__kv_cache_quant_int4_int2_kv_with_per_channel_or_per_token_scales__decode_comb_kernel
.p2align 8
.type standalone__kv_cache_quant_int4_int2_kv_with_per_channel_or_per_token_scales__decode_comb_kernel,@function
standalone__kv_cache_quant_int4_int2_kv_with_per_channel_or_per_token_scales__decode_comb_kernel:
    s_cmp_ge_u32 s2, 128
    s_cbranch_scc1 L2_done
    s_load_dwordx2 s[4:5], s[0:1], 72
    s_load_dwordx2 s[8:9], s[0:1], 56
    s_lshr_b32 s12, s2, 2
    s_and_b32 s13, s2, 3
    v_lshrrev_b32 v1, 3, v0
    v_and_b32 v2, 7, v0
    s_lshr_b32 s14, s12, 3
    s_lshl_b32 s14, s14, 18
    s_and_b32 s15, s12, 7
    s_lshl_b32 s15, s15, 9
    s_add_u32 s14, s14, s15
    s_lshl_b32 s15, s13, 7
    s_add_u32 s14, s14, s15
    v_lshlrev_b32 v3, 15, v1
    v_lshl_add_u32 v3, v2, 4, v3
    s_lshl_b32 s16, s12, 9
    s_add_u32 s16, s16, 0x100000
    v_lshlrev_b32 v4, 6, v1
    s_mov_b32 s17, 0x3fb8aa3b
    s_mov_b32 s6, 0x200000
    s_mov_b32 s7, 0x20000
    s_mov_b32 s10, 8192
    s_mov_b32 s11, 0x20000
    s_waitcnt lgkmcnt(0)
    buffer_load_dwordx4 v[8:11], v4, s[4:7], s16 offen offset:0
    buffer_load_dwordx4 v[12:15], v4, s[4:7], s16 offen offset:16
    buffer_load_dwordx4 v[16:19], v4, s[4:7], s16 offen offset:32
    buffer_load_dwordx4 v[20:23], v4, s[4:7], s16 offen offset:48
    buffer_load_dwordx4 v[24:27], v3, s[4:7], s14 offen
    s_add_u32 s14, s14, 4096
    buffer_load_dwordx4 v[28:31], v3, s[4:7], s14 offen
    s_add_u32 s14, s14, 4096
    buffer_load_dwordx4 v[32:35], v3, s[4:7], s14 offen
    s_add_u32 s14, s14, 4096
    buffer_load_dwordx4 v[36:39], v3, s[4:7], s14 offen
    s_add_u32 s14, s14, 4096
    buffer_load_dwordx4 v[40:43], v3, s[4:7], s14 offen
    s_add_u32 s14, s14, 4096
    buffer_load_dwordx4 v[44:47], v3, s[4:7], s14 offen
    s_add_u32 s14, s14, 4096
    buffer_load_dwordx4 v[48:51], v3, s[4:7], s14 offen
    s_add_u32 s14, s14, 4096
    buffer_load_dwordx4 v[52:55], v3, s[4:7], s14 offen
    s_lshl_b32 s18, s13, 3
    v_add_u32 v5, s18, v2
    v_lshrrev_b32 v6, 2, v5
    v_and_b32 v5, 3, v5
    v_lshl_add_u32 v5, v6, 4, v5
    v_lshlrev_b32 v5, 1, v5
    s_lshl_b32 s18, s12, 8
    s_waitcnt vmcnt(8)
    v_max3_f32 v6, v8, v10, v12
    v_max3_f32 v7, v14, v16, v18
    v_max3_f32 v6, v6, v20, v22
    v_max_f32 v6, v6, v7
    s_nop 1
    v_max_f32_dpp v6, v6, v6 row_ror:8 row_mask:0xf bank_mask:0xf
    v_mov_b32 v7, v6
    s_nop 1
    v_permlane16_swap_b32 v7, v6
    v_max_f32 v6, v6, v7
    v_mov_b32 v7, v6
    s_nop 1
    v_permlane32_swap_b32 v7, v6
    v_max_f32 v6, v6, v7
    v_mul_f32 v6, s17, v6
    v_fma_f32 v8, v8, s17, -v6
    v_fma_f32 v10, v10, s17, -v6
    v_fma_f32 v12, v12, s17, -v6
    v_fma_f32 v14, v14, s17, -v6
    v_fma_f32 v16, v16, s17, -v6
    v_fma_f32 v18, v18, s17, -v6
    v_fma_f32 v20, v20, s17, -v6
    v_fma_f32 v22, v22, s17, -v6
    v_exp_f32 v8, v8
    v_exp_f32 v10, v10
    v_exp_f32 v12, v12
    v_exp_f32 v14, v14
    v_exp_f32 v16, v16
    v_exp_f32 v18, v18
    v_exp_f32 v20, v20
    v_exp_f32 v22, v22
    s_nop 0
    v_mul_f32 v60, v8, v9
    v_fmac_f32 v60, v10, v11
    v_fmac_f32 v60, v12, v13
    v_fmac_f32 v60, v14, v15
    v_fmac_f32 v60, v16, v17
    v_fmac_f32 v60, v18, v19
    v_fmac_f32 v60, v20, v21
    v_fmac_f32 v60, v22, v23
    s_waitcnt vmcnt(7)
    v_mul_f32 v56, v8, v24
    v_mul_f32 v57, v8, v25
    v_mul_f32 v58, v8, v26
    v_mul_f32 v59, v8, v27
    s_waitcnt vmcnt(6)
    v_fmac_f32 v56, v10, v28
    v_fmac_f32 v57, v10, v29
    v_fmac_f32 v58, v10, v30
    v_fmac_f32 v59, v10, v31
    s_waitcnt vmcnt(5)
    v_fmac_f32 v56, v12, v32
    v_fmac_f32 v57, v12, v33
    v_fmac_f32 v58, v12, v34
    v_fmac_f32 v59, v12, v35
    s_waitcnt vmcnt(4)
    v_fmac_f32 v56, v14, v36
    v_fmac_f32 v57, v14, v37
    v_fmac_f32 v58, v14, v38
    v_fmac_f32 v59, v14, v39
    s_waitcnt vmcnt(3)
    v_fmac_f32 v56, v16, v40
    v_fmac_f32 v57, v16, v41
    v_fmac_f32 v58, v16, v42
    v_fmac_f32 v59, v16, v43
    s_waitcnt vmcnt(2)
    v_fmac_f32 v56, v18, v44
    v_fmac_f32 v57, v18, v45
    v_fmac_f32 v58, v18, v46
    v_fmac_f32 v59, v18, v47
    s_waitcnt vmcnt(1)
    v_fmac_f32 v56, v20, v48
    v_fmac_f32 v57, v20, v49
    v_fmac_f32 v58, v20, v50
    v_fmac_f32 v59, v20, v51
    s_waitcnt vmcnt(0)
    v_fmac_f32 v56, v22, v52
    v_fmac_f32 v57, v22, v53
    v_fmac_f32 v58, v22, v54
    v_fmac_f32 v59, v22, v55
    s_nop 1
    v_add_f32_dpp v56, v56, v56 row_ror:8 row_mask:0xf bank_mask:0xf
    v_add_f32_dpp v57, v57, v57 row_ror:8 row_mask:0xf bank_mask:0xf
    v_add_f32_dpp v58, v58, v58 row_ror:8 row_mask:0xf bank_mask:0xf
    v_add_f32_dpp v59, v59, v59 row_ror:8 row_mask:0xf bank_mask:0xf
    v_add_f32_dpp v60, v60, v60 row_ror:8 row_mask:0xf bank_mask:0xf
    v_mov_b32 v8, v56
    v_mov_b32 v9, v57
    v_mov_b32 v10, v58
    v_mov_b32 v11, v59
    v_mov_b32 v12, v60
    v_permlane16_swap_b32 v8, v56
    v_permlane16_swap_b32 v9, v57
    v_permlane16_swap_b32 v10, v58
    v_permlane16_swap_b32 v11, v59
    v_permlane16_swap_b32 v12, v60
    v_add_f32 v56, v56, v8
    v_add_f32 v57, v57, v9
    v_add_f32 v58, v58, v10
    v_add_f32 v59, v59, v11
    v_add_f32 v60, v60, v12
    v_mov_b32 v8, v56
    v_mov_b32 v9, v57
    v_mov_b32 v10, v58
    v_mov_b32 v11, v59
    v_mov_b32 v12, v60
    v_permlane32_swap_b32 v8, v56
    v_permlane32_swap_b32 v9, v57
    v_permlane32_swap_b32 v10, v58
    v_permlane32_swap_b32 v11, v59
    v_permlane32_swap_b32 v12, v60
    v_add_f32 v56, v56, v8
    v_add_f32 v57, v57, v9
    v_add_f32 v58, v58, v10
    v_add_f32 v59, v59, v11
    v_add_f32 v60, v60, v12
    v_rcp_f32 v60, v60
    s_nop 0
    v_mul_f32 v56, v56, v60
    v_mul_f32 v57, v57, v60
    v_mul_f32 v58, v58, v60
    v_mul_f32 v59, v59, v60
    v_cvt_pk_bf16_f32 v56, v56, v57
    v_cvt_pk_bf16_f32 v58, v58, v59
    s_mov_b64 exec, 0xff
    buffer_store_short v56, v5, s[8:11], s18 offen
    buffer_store_short_d16_hi v56, v5, s[8:11], s18 offen offset:8
    buffer_store_short v58, v5, s[8:11], s18 offen offset:16
    buffer_store_short_d16_hi v58, v5, s[8:11], s18 offen offset:24
L2_done:
    s_endpgm
L_code_end:
.section .rodata,"a"
.p2align 6
.amdhsa_kernel standalone__kv_cache_quant_int4_int2_kv_with_per_channel_or_per_token_scales__decode_kernel
  .amdhsa_next_free_vgpr 256
  .amdhsa_next_free_sgpr 96
  .amdhsa_accum_offset 256
  .amdhsa_group_segment_fixed_size 0
  .amdhsa_kernarg_size 80
  .amdhsa_user_sgpr_count 2
  .amdhsa_user_sgpr_kernarg_segment_ptr 1
  .amdhsa_system_sgpr_workgroup_id_x 1
  .amdhsa_float_denorm_mode_32 3
.end_amdhsa_kernel
.section .rodata,"a"
.p2align 6
.amdhsa_kernel standalone__kv_cache_quant_int4_int2_kv_with_per_channel_or_per_token_scales__decode_comb_kernel
  .amdhsa_next_free_vgpr 64
  .amdhsa_next_free_sgpr 32
  .amdhsa_accum_offset 64
  .amdhsa_group_segment_fixed_size 0
  .amdhsa_kernarg_size 80
  .amdhsa_user_sgpr_count 2
  .amdhsa_user_sgpr_kernarg_segment_ptr 1
  .amdhsa_system_sgpr_workgroup_id_x 1
  .amdhsa_float_denorm_mode_32 3
.end_amdhsa_kernel
```
